```python
import torch

def _softmax(x, axis=-1):
    return torch.softmax(x, dim=axis)
def _gelu(x):
    return torch.nn.functional.gelu(x, approximate="tanh")
def _silu(x):
    return torch.nn.functional.silu(x)
def _sigmoid(x):
    return torch.sigmoid(x)
def _layernorm(x, axis=-1, eps=1e-5):
    m = x.mean(dim=axis, keepdim=True)
    v = x.var(dim=axis, keepdim=True, unbiased=False)
    return (x - m) / torch.sqrt(v + eps)
def _scatter_add(tgt, idx, src, axis=0):
    return tgt.clone().index_add_(axis, idx, src)
def _segment_sum(src, seg, n):
    out = torch.zeros((n,) + src.shape[1:], dtype=src.dtype)
    return out.index_add_(0, seg, src)
def _pad(x, pw):
    flat = tuple(v for pair in reversed(pw) for v in pair)
    return torch.nn.functional.pad(x, flat)

kernel_name = 'concat_heads__sliding_local_dilated__spectral_fnet__prompt'

def setup_inputs():

    _w = (lambda a: (lambda t: t.to(torch.bfloat16) if t.is_floating_point() else t)(torch.as_tensor(a)))
    def _A_setup():
        B, S, D = 1, 2048, 1024
        return {
            "x": _w((lambda *s: torch.randn(*s, dtype=torch.bfloat16) * 0.2)(B, S, D)),
            "wqkv": _w((lambda *s: torch.randn(*s, dtype=torch.bfloat16) * 0.8)(D, 3 * D)),
            "wo": _w((lambda *s: torch.randn(*s, dtype=torch.bfloat16) * 0.2)(D, D)),
        }
    _A_in = _A_setup()

    def _B_setup():
        B, S, D = 1, 2048, 1024
        ns = torch.arange(S)[:, None] * torch.arange(S)[None, :]
        nd = torch.arange(D)[:, None] * torch.arange(D)[None, :]
        Ws_re = torch.cos(-2.0 * torch.pi * ns / S).to(float)
        Ws_im = torch.sin(-2.0 * torch.pi * ns / S).to(float)
        Wd_re = torch.cos(-2.0 * torch.pi * nd / D).to(float)
        Wd_im = torch.sin(-2.0 * torch.pi * nd / D).to(float)
        return {
            "x": _w((lambda *s: torch.randn(*s, dtype=torch.bfloat16) * 0.05)(B, S, D)),
            "dft_seq_re": _w(Ws_re),
            "dft_seq_im": _w(Ws_im),
            "dft_hid_re": _w(Wd_re),
            "dft_hid_im": _w(Wd_im),
        }
    _B_in = _B_setup()

    return {
        "A_x": _A_in["x"],
        "A_wqkv": _A_in["wqkv"],
        "A_wo": _A_in["wo"],
        "B_x": _B_in["x"],
        "B_dft_seq_re": _B_in["dft_seq_re"],
        "B_dft_seq_im": _B_in["dft_seq_im"],
        "B_dft_hid_re": _B_in["dft_hid_re"],
        "B_dft_hid_im": _B_in["dft_hid_im"],
    }

def reference(A_x, A_wqkv, A_wo, B_x, B_dft_seq_re, B_dft_seq_im, B_dft_hid_re, B_dft_hid_im):
    def _A_ref(x, wqkv, wo):
        B, S, D = x.shape
        H = 32; Dh = D // H
        W, dil = 8, 2
        qkv = (lambda x, *d: x.permute(*d))((x @ wqkv).reshape(B, S, 3, H, Dh), 2, 0, 3, 1, 4)
        q, k, v = qkv[0], qkv[1], qkv[2]
        scale = Dh ** -0.5
        pos = torch.arange(S)
        off = torch.arange(W) * dil
        idx = pos[:, None] - off[None, :]
        mask = idx >= 0
        idx_c = torch.where(mask, idx, 0).reshape(-1)
        kg = k[:, :, idx_c, :].reshape(B, H, S, W, Dh)
        vg = v[:, :, idx_c, :].reshape(B, H, S, W, Dh)
        logits = torch.einsum("bhsd,bhswd->bhsw", q, kg) * scale
        logits = torch.where(mask[None, None, :, :], logits, -1e9)
        attn = _softmax(logits, axis=-1)
        o = torch.einsum("bhsw,bhswd->bhsd", attn, vg)
        return (lambda x, *d: x.permute(*d))(o, 0, 2, 1, 3).reshape(B, S, D) @ wo

    def _B_ref(x, dft_seq_re, dft_seq_im, dft_hid_re, dft_hid_im):
        a = torch.einsum("bsd,ed->bse", x, dft_hid_re)
        b = torch.einsum("bsd,ed->bse", x, dft_hid_im)
        y = torch.einsum("ts,bse->bte", dft_seq_re, a) - torch.einsum("ts,bse->bte", dft_seq_im, b)
        return y

    a = _A_ref(A_x, A_wqkv, A_wo)
    b = _B_ref(B_x, B_dft_seq_re, B_dft_seq_im, B_dft_hid_re, B_dft_hid_im)
    return torch.concatenate([a, b], axis=-1)
```

```asm
; @launch grid=(256,1,1) block=(512,1,1) lds=163840
.amdgcn_target "amdgcn-amd-amdhsa--gfx950"
.text
.globl concat_heads__sliding_local_dilated__spectral_fnet__prompt_kernel
.p2align 8
.type concat_heads__sliding_local_dilated__spectral_fnet__prompt_kernel,@function
concat_heads__sliding_local_dilated__spectral_fnet__prompt_kernel:
    s_load_dwordx2 s[16:17], s[0:1], 0
    s_load_dwordx2 s[20:21], s[0:1], 8
    s_load_dwordx2 s[28:29], s[0:1], 24
    s_load_dwordx2 s[36:37], s[0:1], 80
    s_load_dwordx2 s[24:25], s[0:1], 16
    s_load_dwordx2 s[32:33], s[0:1], 64
    s_load_dwordx2 s[12:13], s[0:1], 72
    s_cmp_ge_u32 s2, 256
    s_cbranch_scc1 L_end
    v_lshrrev_b32 v1, 6, v0
    v_and_b32 v2, 63, v0
    s_and_b32 s4, s2, 7
    v_readfirstlane_b32 s3, v1
    s_lshr_b32 s5, s2, 3
    s_and_b32 s6, s4, 1
    s_lshl_b32 s6, s6, 3
    s_and_b32 s40, s5, 7
    s_add_u32 s6, s6, s40
    s_lshr_b32 s7, s4, 1
    s_lshl_b32 s7, s7, 2
    s_lshr_b32 s40, s5, 3
    s_add_u32 s7, s7, s40
    s_mov_b32 s18, 0x400000
    s_mov_b32 s19, 0x20000
    s_mov_b32 s22, 0x600000
    s_mov_b32 s23, 0x20000
    s_mov_b32 s26, 0x200000
    s_mov_b32 s27, 0x20000
    s_mov_b32 s30, 0x400000
    s_mov_b32 s31, 0x20000
    s_mov_b32 s34, 0x800000
    s_mov_b32 s35, 0x20000
    s_mov_b32 s38, 0x1000000
    s_mov_b32 s39, 0x20000
    s_mov_b32 s14, 0x10
    s_mov_b32 s15, 0x20000
    s_lshr_b32 s9, s5, 1
    s_lshr_b32 s41, s4, 1
    s_lshl_b32 s41, s41, 2
    s_and_b32 s42, s5, 3
    s_add_u32 s8, s41, s42
    s_and_b32 s41, s4, 1
    s_lshl_b32 s41, s41, 3
    s_lshr_b32 s43, s5, 2
    s_add_u32 s11, s41, s43
    s_add_u32 s10, s42, s43
    s_and_b32 s10, s10, 3
    s_lshl_b32 s10, s10, 2
    s_cmp_lt_u32 s3, 4
    s_cbranch_scc1 L_compute
    s_sub_u32 s3, s3, 4
    v_lshrrev_b32 v3, 3, v2
    v_and_b32 v4, 7, v2
    v_lshrrev_b32 v5, 4, v2
    s_and_b32 s41, s3, 1
    s_lshl_b32 s42, s41, 2
    v_add_u32 v6, s42, v5
    v_xor_b32 v6, v6, v4
    v_lshlrev_b32 v6, 4, v6
    s_lshl_b32 s42, s6, 7
    s_lshl_b32 s43, s3, 3
    s_add_u32 s42, s42, s43
    s_sub_u32 s42, s42, 16
    v_add_u32 v7, s42, v3
    v_lshl_add_u32 v11, v7, 11, v6
    s_cmp_lt_i32 s42, 0
    s_cselect_b32 s43, 0x8000, 0
    s_lshl_b32 s46, s3, 10
    v_add_u32 v10, s43, v11
    v_add_u32 v14, 262144, v11
    v_add_u32 v13, 196608, v11
    v_add_u32 v12, 131072, v11
    v_add_u32 v11, 65536, v11
    v_and_b32 v7, 1, v5
    s_lshl_b32 s42, s41, 1
    v_add_u32 v7, s42, v7
    v_lshlrev_b32 v7, 1, v7
    v_xor_b32 v7, v7, v4
    v_lshlrev_b32 v7, 4, v7
    s_lshl_b32 s42, s3, 3
    v_add_u32 v8, s42, v3
    v_mul_u32_u24 v8, 6144, v8
    s_lshl_b32 s42, s7, 7
    v_add3_u32 v16, v7, v8, s42
    v_add_u32 v17, 196608, v16
    v_add_u32 v18, 2048, v16
    v_add_u32 v19, 198656, v16
    v_add_u32 v20, 4096, v16
    v_add_u32 v21, 200704, v16
    s_lshr_b32 s42, s6, 2
    s_lshr_b32 s43, s7, 2
    s_add_u32 s42, s42, s43
    s_and_b32 s42, s42, 3
    s_lshl_b32 s44, s42, 9
    s_mul_i32 s45, s42, 1572864
    s_waitcnt lgkmcnt(0)
    s_add_u32 m0, s46, 16384
    s_cmp_ge_u32 s3, 2
    s_cbranch_scc1 L_x5_1
    buffer_load_dwordx4 v14, s[16:19], s44 offen lds
L_x5_1:
    s_add_u32 m0, s46, 0
    s_nop 0
    buffer_load_dwordx4 v10, s[16:19], s44 offen lds
    s_add_u32 m0, s46, 4096
    s_nop 0
    buffer_load_dwordx4 v11, s[16:19], s44 offen lds
    s_add_u32 m0, s46, 8192
    s_nop 0
    buffer_load_dwordx4 v12, s[16:19], s44 offen lds
    s_add_u32 m0, s46, 12288
    s_nop 0
    buffer_load_dwordx4 v13, s[16:19], s44 offen lds
    s_add_u32 m0, s46, 18432
    s_nop 0
    buffer_load_dwordx4 v16, s[20:23], s45 offen lds
    s_add_u32 m0, s46, 22528
    s_lshl_b32 s49, s3, 2
    v_and_b32 v120, 3, v2
    v_add_u32 v120, s49, v120
    v_bfe_u32 v121, v2, 2, 1
    v_cvt_f32_u32 v122, v121
    v_mul_f32 v122, 0x3e800000, v122
    v_cmp_eq_u32 vcc, 0, v120
    v_lshlrev_b32 v121, 4, v121
    s_nop 0
    v_cndmask_b32 v120, v120, v121, vcc
    v_cndmask_b32 v122, v122, 0, vcc
    v_cvt_f32_u32 v120, v120
    v_mul_f32 v123, 0x3d000000, v120
    v_cvt_f32_u32 v124, v5
    v_mul_f32 v124, 0x41000000, v124
    v_fma_f32 v122, v123, v124, v122
    v_cos_f32 v128, v122
    buffer_load_dwordx4 v17, s[20:23], s45 offen lds
    s_add_u32 m0, s46, 26624
    v_add_f32 v122, v122, v123
    v_cos_f32 v129, v122
    v_add_f32 v122, v122, v123
    v_cos_f32 v130, v122
    v_add_f32 v122, v122, v123
    v_cos_f32 v131, v122
    v_add_f32 v122, v122, v123
    v_cos_f32 v132, v122
    v_add_f32 v122, v122, v123
    v_cos_f32 v133, v122
    v_add_f32 v122, v122, v123
    v_cos_f32 v134, v122
    v_add_f32 v122, v122, v123
    v_cos_f32 v135, v122
    v_cvt_pk_bf16_f32 v140, v128, v129
    v_cvt_pk_bf16_f32 v141, v130, v131
    v_cvt_pk_bf16_f32 v142, v132, v133
    buffer_load_dwordx4 v18, s[20:23], s45 offen lds
    s_add_u32 m0, s46, 30720
    v_cvt_pk_bf16_f32 v143, v134, v135
    s_mov_b32 s50, 0x00ff00ff
    s_mov_b32 s51, 0x00ff00ff
    v_cndmask_b32 v24, 0, v140, s[50:51]
    v_cndmask_b32 v232, v140, 0, s[50:51]
    v_cndmask_b32 v25, 0, v141, s[50:51]
    v_cndmask_b32 v233, v141, 0, s[50:51]
    v_cndmask_b32 v26, 0, v142, s[50:51]
    v_cndmask_b32 v234, v142, 0, s[50:51]
    v_cndmask_b32 v27, 0, v143, s[50:51]
    v_cndmask_b32 v235, v143, 0, s[50:51]
    v_bfe_u32 v136, v2, 1, 3
    v_and_b32 v137, 1, v2
    v_bfe_u32 v120, v2, 4, 1
    v_sub_u32 v121, v137, v120
    v_cvt_f32_i32 v138, v121
    buffer_load_dwordx4 v19, s[20:23], s45 offen lds
    s_add_u32 m0, s46, 34816
    v_mul_f32 v138, 0x3e800000, v138
    v_mov_b32 v139, s49
    v_lshl_add_u32 v125, v136, 5, v139
    v_cvt_f32_u32 v126, s4
    v_mul_f32 v126, 0x3a000000, v126
    s_mov_b32 s50, -1
    s_mov_b32 s51, 0
    v_cmp_eq_u32 s[52:53], 0, v139
    v_cmp_eq_u32 vcc, 1, v120
    s_nop 0
    s_and_b64 s[54:55], s[52:53], vcc
    v_lshlrev_b32 v121, 5, v136
    v_subrev_u32 v121, 112, v121
    v_cndmask_b32 v121, v125, v121, s[54:55]
    v_cvt_f32_u32 v124, v137
    v_mul_f32 v124, 0x3e800000, v124
    v_cndmask_b32 v124, v138, v124, s[52:53]
    v_cvt_f32_i32 v121, v121
    buffer_load_dwordx4 v20, s[20:23], s45 offen lds
    s_add_u32 m0, s46, 38912
    v_fma_f32 v122, v121, v126, v124
    v_mul_f32 v123, 0x3b800000, v121
    v_lshrrev_b32 v121, 2, v136
    v_cmp_ne_u32 vcc, v121, v120
    s_nop 0
    s_and_b64 s[54:55], s[52:53], vcc
    v_mov_b32 v124, 0x3e800000
    v_cndmask_b32 v122, v122, v124, s[54:55]
    v_cndmask_b32 v123, v123, 0, s[54:55]
    v_and_b32 v121, 31, v2
    v_cmp_eq_u32 vcc, 1, v121
    s_nop 0
    s_and_b64 s[54:55], s[52:53], vcc
    v_cndmask_b32 v122, v122, 0, s[54:55]
    v_cndmask_b32 v123, v123, 0.5, s[54:55]
    v_cos_f32 v128, v122
    v_add_f32 v122, v122, v123
    v_cos_f32 v129, v122
    buffer_load_dwordx4 v21, s[20:23], s45 offen lds
    s_add_u32 s44, s44, 128
    s_and_b32 s44, s44, 2047
    s_add_u32 s45, s45, 393216
    s_cmp_ge_u32 s45, 0x600000
    s_cselect_b32 s45, 0, s45
    s_add_u32 m0, s46, 59392
    s_cmp_ge_u32 s3, 2
    s_cbranch_scc1 L_x5_2
    buffer_load_dwordx4 v14, s[16:19], s44 offen lds
L_x5_2:
    s_add_u32 m0, s46, 43008
    v_add_f32 v122, v122, v123
    v_cos_f32 v130, v122
    v_add_f32 v122, v122, v123
    v_cos_f32 v131, v122
    v_add_f32 v122, v122, v123
    v_cos_f32 v132, v122
    v_add_f32 v122, v122, v123
    v_cos_f32 v133, v122
    v_add_f32 v122, v122, v123
    v_cos_f32 v134, v122
    v_add_f32 v122, v122, v123
    v_cos_f32 v135, v122
    v_cvt_pk_bf16_f32 v140, v128, v129
    v_cvt_pk_bf16_f32 v141, v130, v131
    v_cvt_pk_bf16_f32 v142, v132, v133
    v_cvt_pk_bf16_f32 v143, v134, v135
    v_cndmask_b32 v28, 0, v140, s[50:51]
    buffer_load_dwordx4 v10, s[16:19], s44 offen lds
    s_add_u32 m0, s46, 47104
    v_cndmask_b32 v32, v140, 0, s[50:51]
    v_cndmask_b32 v29, 0, v141, s[50:51]
    v_cndmask_b32 v33, v141, 0, s[50:51]
    v_cndmask_b32 v30, 0, v142, s[50:51]
    v_cndmask_b32 v34, v142, 0, s[50:51]
    v_cndmask_b32 v31, 0, v143, s[50:51]
    v_cndmask_b32 v35, v143, 0, s[50:51]
    v_add_u32 v121, 1, v125
    v_cvt_f32_u32 v121, v121
    v_fma_f32 v122, v121, v126, v138
    v_mul_f32 v123, 0x3b800000, v121
    v_cos_f32 v128, v122
    v_add_f32 v122, v122, v123
    v_cos_f32 v129, v122
    v_add_f32 v122, v122, v123
    v_cos_f32 v130, v122
    v_add_f32 v122, v122, v123
    buffer_load_dwordx4 v11, s[16:19], s44 offen lds
    s_add_u32 m0, s46, 51200
    v_cos_f32 v131, v122
    v_add_f32 v122, v122, v123
    v_cos_f32 v132, v122
    v_add_f32 v122, v122, v123
    v_cos_f32 v133, v122
    v_add_f32 v122, v122, v123
    v_cos_f32 v134, v122
    v_add_f32 v122, v122, v123
    v_cos_f32 v135, v122
    v_cvt_pk_bf16_f32 v140, v128, v129
    v_cvt_pk_bf16_f32 v141, v130, v131
    v_cvt_pk_bf16_f32 v142, v132, v133
    v_cvt_pk_bf16_f32 v143, v134, v135
    v_cndmask_b32 v36, 0, v140, s[50:51]
    v_cndmask_b32 v40, v140, 0, s[50:51]
    v_cndmask_b32 v37, 0, v141, s[50:51]
    buffer_load_dwordx4 v12, s[16:19], s44 offen lds
    s_add_u32 m0, s46, 55296
    v_cndmask_b32 v41, v141, 0, s[50:51]
    v_cndmask_b32 v38, 0, v142, s[50:51]
    v_cndmask_b32 v42, v142, 0, s[50:51]
    v_cndmask_b32 v39, 0, v143, s[50:51]
    v_cndmask_b32 v43, v143, 0, s[50:51]
    v_add_u32 v121, 2, v125
    v_cvt_f32_u32 v121, v121
    v_fma_f32 v122, v121, v126, v138
    v_mul_f32 v123, 0x3b800000, v121
    v_cos_f32 v128, v122
    v_add_f32 v122, v122, v123
    v_cos_f32 v129, v122
    v_add_f32 v122, v122, v123
    v_cos_f32 v130, v122
    v_add_f32 v122, v122, v123
    v_cos_f32 v131, v122
    v_add_f32 v122, v122, v123
    buffer_load_dwordx4 v13, s[16:19], s44 offen lds
    s_add_u32 m0, s46, 61440
    v_cos_f32 v132, v122
    v_add_f32 v122, v122, v123
    v_cos_f32 v133, v122
    v_add_f32 v122, v122, v123
    v_cos_f32 v134, v122
    v_add_f32 v122, v122, v123
    v_cos_f32 v135, v122
    v_cvt_pk_bf16_f32 v140, v128, v129
    v_cvt_pk_bf16_f32 v141, v130, v131
    v_cvt_pk_bf16_f32 v142, v132, v133
    v_cvt_pk_bf16_f32 v143, v134, v135
    v_cndmask_b32 v44, 0, v140, s[50:51]
    v_cndmask_b32 v48, v140, 0, s[50:51]
    v_cndmask_b32 v45, 0, v141, s[50:51]
    v_cndmask_b32 v49, v141, 0, s[50:51]
    v_cndmask_b32 v46, 0, v142, s[50:51]
    buffer_load_dwordx4 v16, s[20:23], s45 offen lds
    s_add_u32 m0, s46, 65536
    v_cndmask_b32 v50, v142, 0, s[50:51]
    v_cndmask_b32 v47, 0, v143, s[50:51]
    v_cndmask_b32 v51, v143, 0, s[50:51]
    v_add_u32 v121, 3, v125
    v_cvt_f32_u32 v121, v121
    v_fma_f32 v122, v121, v126, v138
    v_mul_f32 v123, 0x3b800000, v121
    v_cos_f32 v128, v122
    v_add_f32 v122, v122, v123
    v_cos_f32 v129, v122
    v_add_f32 v122, v122, v123
    v_cos_f32 v130, v122
    v_add_f32 v122, v122, v123
    v_cos_f32 v131, v122
    v_add_f32 v122, v122, v123
    v_cos_f32 v132, v122
    v_add_f32 v122, v122, v123
    buffer_load_dwordx4 v17, s[20:23], s45 offen lds
    s_add_u32 m0, s46, 69632
    v_cos_f32 v133, v122
    v_add_f32 v122, v122, v123
    v_cos_f32 v134, v122
    v_add_f32 v122, v122, v123
    v_cos_f32 v135, v122
    v_cvt_pk_bf16_f32 v140, v128, v129
    v_cvt_pk_bf16_f32 v141, v130, v131
    v_cvt_pk_bf16_f32 v142, v132, v133
    v_cvt_pk_bf16_f32 v143, v134, v135
    v_cndmask_b32 v52, 0, v140, s[50:51]
    v_cndmask_b32 v56, v140, 0, s[50:51]
    v_cndmask_b32 v53, 0, v141, s[50:51]
    v_cndmask_b32 v57, v141, 0, s[50:51]
    v_cndmask_b32 v54, 0, v142, s[50:51]
    v_cndmask_b32 v58, v142, 0, s[50:51]
    v_cndmask_b32 v55, 0, v143, s[50:51]
    v_cndmask_b32 v59, v143, 0, s[50:51]
    buffer_load_dwordx4 v18, s[20:23], s45 offen lds
    s_and_b32 s41, s5, 0
    s_cmp_lg_u32 s41, 0
    s_cbranch_scc1 L_nox_17
    v_lshrrev_b32 v7, 5, v2
    v_lshlrev_b32 v7, 1, v7
    v_and_b32 v8, 3, v2
    v_xor_b32 v7, v7, v8
    v_lshlrev_b32 v7, 4, v7
    v_lshrrev_b32 v8, 2, v2
    v_lshl_add_u32 v22, v8, 17, v7
    s_lshl_b32 s41, s4, 11
    s_lshl_b32 s42, s5, 6
    s_add_u32 s41, s41, s42
    s_lshl_b32 s42, s3, 15
    s_add_u32 s41, s41, s42
    s_lshl_b32 s43, s3, 12
    s_add_u32 m0, s43, 131072
    s_add_u32 s42, s41, 0
    buffer_load_dwordx4 v22, s[28:31], s42 offen nt lds
    s_add_u32 m0, s43, 132096
    s_add_u32 s42, s41, 2097152
    buffer_load_dwordx4 v22, s[28:31], s42 offen nt lds
    s_add_u32 m0, s43, 133120
    s_add_u32 s42, s41, 16384
    buffer_load_dwordx4 v22, s[28:31], s42 offen nt lds
    s_add_u32 m0, s43, 134144
    s_add_u32 s42, s41, 2113536
    buffer_load_dwordx4 v22, s[28:31], s42 offen nt lds
L_nox_17:
    s_waitcnt vmcnt(7)
    s_barrier
    s_add_u32 m0, s46, 73728
    v_lshlrev_b32 v6, 4, v2
    v_add_u32 v6, 147456, v6
    buffer_load_dwordx4 v19, s[20:23], s45 offen lds
    s_add_u32 m0, s46, 77824
    ds_read_b128 v[60:63], v6 offset:0
    ds_read_b128 v[64:67], v6 offset:1024
    buffer_load_dwordx4 v20, s[20:23], s45 offen lds
    s_add_u32 m0, s46, 81920
    ds_read_b128 v[68:71], v6 offset:2048
    ds_read_b128 v[72:75], v6 offset:3072
    buffer_load_dwordx4 v21, s[20:23], s45 offen lds
    s_add_u32 s44, s44, 128
    s_and_b32 s44, s44, 2047
    s_add_u32 s45, s45, 393216
    s_cmp_ge_u32 s45, 0x600000
    s_cselect_b32 s45, 0, s45
    s_add_u32 m0, s46, 102400
    s_cmp_ge_u32 s3, 2
    s_cbranch_scc1 L_x5_3
    buffer_load_dwordx4 v14, s[16:19], s44 offen lds
L_x5_3:
    s_add_u32 m0, s46, 86016
    ds_read_b128 v[76:79], v6 offset:4096
    ds_read_b128 v[80:83], v6 offset:5120
    ds_read_b128 v[84:87], v6 offset:6144
    buffer_load_dwordx4 v10, s[16:19], s44 offen lds
    s_add_u32 m0, s46, 90112
    ds_read_b128 v[88:91], v6 offset:7168
    ds_read_b128 v[92:95], v6 offset:8192
    buffer_load_dwordx4 v11, s[16:19], s44 offen lds
    s_add_u32 m0, s46, 94208
    ds_read_b128 v[96:99], v6 offset:9216
    ds_read_b128 v[100:103], v6 offset:10240
    buffer_load_dwordx4 v12, s[16:19], s44 offen lds
    s_add_u32 m0, s46, 98304
    ds_read_b128 v[104:107], v6 offset:11264
    ds_read_b128 v[108:111], v6 offset:12288
    ds_read_b128 v[112:115], v6 offset:13312
    buffer_load_dwordx4 v13, s[16:19], s44 offen lds
    s_add_u32 m0, s46, 104448
    ds_read_b128 v[116:119], v6 offset:14336
    v_lshlrev_b32 v7, 1, v5
    buffer_load_dwordx4 v16, s[20:23], s45 offen lds
    s_add_u32 m0, s46, 108544
    v_xor_b32 v7, v7, v4
    v_lshlrev_b32 v7, 4, v7
    buffer_load_dwordx4 v17, s[20:23], s45 offen lds
    s_add_u32 m0, s46, 112640
    v_lshl_add_u32 v7, v3, 11, v7
    s_lshl_b32 s41, s11, 7
    v_add_u32 v23, s41, v7
    buffer_load_dwordx4 v18, s[20:23], s45 offen lds
    s_waitcnt vmcnt(7) lgkmcnt(0)
    s_barrier
    s_setprio 2
    s_add_u32 m0, s46, 116736
    v_bfe_u32 v6, v2, 2, 2
    v_lshl_add_u32 v6, v5, 3, v6
    v_lshlrev_b32 v6, 6, v6
    v_and_b32 v7, 3, v2
    v_lshl_add_u32 v6, v7, 3, v6
    v_and_b32 v7, 1, v5
    v_lshl_add_u32 v6, v7, 5, v6
    buffer_load_dwordx4 v19, s[20:23], s45 offen lds
    s_add_u32 m0, s46, 120832
    v_add_u32 v6, 131072, v6
    v_xor_b32 v7, 32, v6
    ds_read_b64_tr_b16 v[120:121], v6 offset:0
    ds_read_b64_tr_b16 v[122:123], v6 offset:256
    ds_read_b64_tr_b16 v[124:125], v6 offset:2048
    ds_read_b64_tr_b16 v[126:127], v6 offset:2304
    ds_read_b64_tr_b16 v[128:129], v6 offset:4096
    buffer_load_dwordx4 v20, s[20:23], s45 offen lds
    s_add_u32 m0, s46, 124928
    ds_read_b64_tr_b16 v[130:131], v6 offset:4352
    ds_read_b64_tr_b16 v[132:133], v6 offset:6144
    ds_read_b64_tr_b16 v[134:135], v6 offset:6400
    ds_read_b64_tr_b16 v[136:137], v6 offset:8192
    ds_read_b64_tr_b16 v[138:139], v6 offset:8448
    ds_read_b64_tr_b16 v[140:141], v6 offset:10240
    ds_read_b64_tr_b16 v[142:143], v6 offset:10496
    buffer_load_dwordx4 v21, s[20:23], s45 offen lds
    s_add_u32 s44, s44, 128
    s_and_b32 s44, s44, 2047
    s_add_u32 s45, s45, 393216
    s_cmp_ge_u32 s45, 0x600000
    s_cselect_b32 s45, 0, s45
    s_add_u32 m0, s46, 16384
    s_cmp_ge_u32 s3, 2
    s_cbranch_scc1 L_x5_4
    buffer_load_dwordx4 v14, s[16:19], s44 offen lds
L_x5_4:
    s_add_u32 m0, s46, 0
    ds_read_b64_tr_b16 v[144:145], v6 offset:12288
    ds_read_b64_tr_b16 v[146:147], v6 offset:12544
    ds_read_b64_tr_b16 v[148:149], v6 offset:14336
    ds_read_b64_tr_b16 v[150:151], v6 offset:14592
    s_waitcnt lgkmcnt(0)
    v_mfma_f32_16x16x32_bf16 v[152:155], v[24:27], v[120:123], 0
    v_mfma_f32_16x16x32_bf16 v[156:159], v[24:27], v[124:127], 0
    v_mfma_f32_16x16x32_bf16 v[160:163], v[24:27], v[128:131], 0
    v_mfma_f32_16x16x32_bf16 v[164:167], v[24:27], v[132:135], 0
    buffer_load_dwordx4 v10, s[16:19], s44 offen lds
    s_add_u32 m0, s46, 4096
    v_mfma_f32_16x16x32_bf16 v[168:171], v[24:27], v[136:139], 0
    v_mfma_f32_16x16x32_bf16 v[172:175], v[24:27], v[140:143], 0
    v_mfma_f32_16x16x32_bf16 v[176:179], v[24:27], v[144:147], 0
    v_mfma_f32_16x16x32_bf16 v[180:183], v[24:27], v[148:151], 0
    ds_read_b64_tr_b16 v[184:185], v7 offset:0
    ds_read_b64_tr_b16 v[186:187], v7 offset:256
    ds_read_b64_tr_b16 v[188:189], v7 offset:2048
    buffer_load_dwordx4 v11, s[16:19], s44 offen lds
    s_add_u32 m0, s46, 8192
    ds_read_b64_tr_b16 v[190:191], v7 offset:2304
    ds_read_b64_tr_b16 v[192:193], v7 offset:4096
    ds_read_b64_tr_b16 v[194:195], v7 offset:4352
    ds_read_b64_tr_b16 v[196:197], v7 offset:6144
    ds_read_b64_tr_b16 v[198:199], v7 offset:6400
    ds_read_b64_tr_b16 v[200:201], v7 offset:8192
    ds_read_b64_tr_b16 v[202:203], v7 offset:8448
    buffer_load_dwordx4 v12, s[16:19], s44 offen lds
    s_add_u32 m0, s46, 12288
    ds_read_b64_tr_b16 v[204:205], v7 offset:10240
    ds_read_b64_tr_b16 v[206:207], v7 offset:10496
    ds_read_b64_tr_b16 v[208:209], v7 offset:12288
    ds_read_b64_tr_b16 v[210:211], v7 offset:12544
    ds_read_b64_tr_b16 v[212:213], v7 offset:14336
    ds_read_b64_tr_b16 v[214:215], v7 offset:14592
    s_waitcnt lgkmcnt(0)
    v_mfma_f32_16x16x32_bf16 v[152:155], v[232:235], v[184:187], v[152:155]
    v_mfma_f32_16x16x32_bf16 v[156:159], v[232:235], v[188:191], v[156:159]
    buffer_load_dwordx4 v13, s[16:19], s44 offen lds
    s_add_u32 m0, s46, 18432
    v_mfma_f32_16x16x32_bf16 v[160:163], v[232:235], v[192:195], v[160:163]
    v_mfma_f32_16x16x32_bf16 v[164:167], v[232:235], v[196:199], v[164:167]
    v_mfma_f32_16x16x32_bf16 v[168:171], v[232:235], v[200:203], v[168:171]
    v_mfma_f32_16x16x32_bf16 v[172:175], v[232:235], v[204:207], v[172:175]
    v_mfma_f32_16x16x32_bf16 v[176:179], v[232:235], v[208:211], v[176:179]
    v_mfma_f32_16x16x32_bf16 v[180:183], v[232:235], v[212:215], v[180:183]
    v_cvt_pk_bf16_f32 v184, v152, v156
    buffer_load_dwordx4 v16, s[20:23], s45 offen lds
    s_add_u32 m0, s46, 22528
    s_nop 0
    v_cvt_pk_bf16_f32 v185, v160, v164
    s_nop 0
    v_cvt_pk_bf16_f32 v186, v168, v172
    s_nop 0
    v_cvt_pk_bf16_f32 v187, v176, v180
    v_cvt_pk_bf16_f32 v188, v153, v157
    v_cvt_pk_bf16_f32 v189, v161, v165
    v_cvt_pk_bf16_f32 v190, v169, v173
    v_cvt_pk_bf16_f32 v191, v177, v181
    buffer_load_dwordx4 v17, s[20:23], s45 offen lds
    s_add_u32 m0, s46, 26624
    v_cvt_pk_bf16_f32 v192, v154, v158
    v_cvt_pk_bf16_f32 v193, v162, v166
    v_cvt_pk_bf16_f32 v194, v170, v174
    v_cvt_pk_bf16_f32 v195, v178, v182
    v_cvt_pk_bf16_f32 v196, v155, v159
    v_cvt_pk_bf16_f32 v197, v163, v167
    v_cvt_pk_bf16_f32 v198, v171, v175
    v_cvt_pk_bf16_f32 v199, v179, v183
    buffer_load_dwordx4 v18, s[20:23], s45 offen lds
    s_setprio 0
    s_waitcnt vmcnt(7)
    s_barrier
    s_setprio 2
    s_add_u32 m0, s46, 30720
    v_mfma_f32_16x16x32_bf16 v[120:123], v[184:187], v[28:31], 0
    v_mfma_f32_16x16x32_bf16 v[124:127], v[184:187], v[32:35], 0
    v_mfma_f32_16x16x32_bf16 v[128:131], v[188:191], v[36:39], 0
    v_mfma_f32_16x16x32_bf16 v[132:135], v[188:191], v[40:43], 0
    buffer_load_dwordx4 v19, s[20:23], s45 offen lds
    s_add_u32 m0, s46, 34816
    v_mfma_f32_16x16x32_bf16 v[136:139], v[192:195], v[44:47], 0
    v_mfma_f32_16x16x32_bf16 v[140:143], v[192:195], v[48:51], 0
    v_mfma_f32_16x16x32_bf16 v[144:147], v[196:199], v[52:55], 0
    v_mfma_f32_16x16x32_bf16 v[148:151], v[196:199], v[56:59], 0
    v_bfe_u32 v231, v2, 1, 3
    buffer_load_dwordx4 v20, s[20:23], s45 offen lds
    s_add_u32 m0, s46, 38912
    v_lshlrev_b32 v231, 15, v231
    v_and_b32 v8, 1, v2
    v_lshl_add_u32 v231, v8, 11, v231
    v_and_b32 v8, 1, v5
    v_lshl_add_u32 v231, v8, 5, v231
    buffer_load_dwordx4 v21, s[20:23], s45 offen lds
    s_add_u32 s44, s44, 128
    s_and_b32 s44, s44, 2047
    s_add_u32 s45, s45, 393216
    s_cmp_ge_u32 s45, 0x600000
    s_cselect_b32 s45, 0, s45
    s_add_u32 m0, s46, 59392
    s_cmp_ge_u32 s3, 2
    s_cbranch_scc1 L_x5_5
    buffer_load_dwordx4 v14, s[16:19], s44 offen lds
L_x5_5:
    s_add_u32 m0, s46, 43008
    v_lshrrev_b32 v8, 5, v2
    v_lshl_add_u32 v231, v8, 4, v231
    s_lshl_b32 s41, s3, 20
    s_lshl_b32 s42, s4, 12
    s_add_u32 s41, s41, s42
    buffer_load_dwordx4 v10, s[16:19], s44 offen lds
    s_add_u32 m0, s46, 47104
    s_lshl_b32 s42, s5, 6
    s_add_u32 s41, s41, s42
    s_add_u32 s41, s41, 4194304
    v_cvt_pk_bf16_f32 v200, v120, v121
    v_cvt_pk_bf16_f32 v201, v122, v123
    buffer_load_dwordx4 v11, s[16:19], s44 offen lds
    s_add_u32 m0, s46, 51200
    v_cvt_pk_bf16_f32 v202, v124, v125
    v_cvt_pk_bf16_f32 v203, v126, v127
    v_cvt_pk_bf16_f32 v204, v128, v129
    v_cvt_pk_bf16_f32 v205, v130, v131
    buffer_load_dwordx4 v12, s[16:19], s44 offen lds
    s_add_u32 m0, s46, 55296
    v_cvt_pk_bf16_f32 v206, v132, v133
    v_cvt_pk_bf16_f32 v207, v134, v135
    v_cvt_pk_bf16_f32 v208, v136, v137
    v_cvt_pk_bf16_f32 v209, v138, v139
    v_cvt_pk_bf16_f32 v210, v140, v141
    buffer_load_dwordx4 v13, s[16:19], s44 offen lds
    s_add_u32 m0, s46, 61440
    v_cvt_pk_bf16_f32 v211, v142, v143
    v_cvt_pk_bf16_f32 v212, v144, v145
    v_cvt_pk_bf16_f32 v213, v146, v147
    v_cvt_pk_bf16_f32 v214, v148, v149
    v_cvt_pk_bf16_f32 v215, v150, v151
    buffer_load_dwordx4 v16, s[20:23], s45 offen lds
    s_add_u32 m0, s46, 65536
    v_permlane16_swap_b32 v200, v202
    v_permlane16_swap_b32 v201, v203
    v_permlane16_swap_b32 v204, v206
    v_permlane16_swap_b32 v205, v207
    v_permlane16_swap_b32 v208, v210
    buffer_load_dwordx4 v17, s[20:23], s45 offen lds
    s_add_u32 m0, s46, 69632
    v_permlane16_swap_b32 v209, v211
    v_permlane16_swap_b32 v212, v214
    v_permlane16_swap_b32 v213, v215
    s_mov_b32 s56, s41
    s_and_b32 s57, s5, 3
    buffer_load_dwordx4 v18, s[20:23], s45 offen lds
    s_setprio 0
    s_waitcnt vmcnt(7)
    s_barrier
    s_add_u32 m0, s46, 73728
    s_lshl_b32 s41, s4, 4
    s_add_u32 s41, s41, s9
    s_lshr_b32 s42, s41, 3
    s_and_b32 s43, s41, 7
    s_lshl_b32 s47, s43, 5
    buffer_load_dwordx4 v19, s[20:23], s45 offen lds
    s_add_u32 m0, s46, 77824
    s_add_u32 s48, s47, s42
    s_sub_u32 s47, s47, 112
    s_cmp_ge_u32 s41, 4
    s_cselect_b32 s47, s47, s48
    s_cmp_ge_u32 s41, 8
    s_cselect_b32 s48, s48, s47
    s_and_b32 s43, s5, 1
    s_lshl_b32 s47, s43, 2
    buffer_load_dwordx4 v20, s[20:23], s45 offen lds
    s_add_u32 m0, s46, 81920
    s_add_u32 s47, s47, s3
    s_lshl_b32 s47, s47, 8
    s_add_u32 s50, s48, s47
    s_lshl_b32 s47, s43, 7
    s_lshl_b32 s48, s3, 8
    s_add_u32 s47, s47, s48
    buffer_load_dwordx4 v21, s[20:23], s45 offen lds
    s_add_u32 s44, s44, 128
    s_and_b32 s44, s44, 2047
    s_add_u32 s45, s45, 393216
    s_cmp_ge_u32 s45, 0x600000
    s_cselect_b32 s45, 0, s45
    s_add_u32 m0, s46, 102400
    s_cmp_ge_u32 s3, 2
    s_cbranch_scc1 L_x5_6
    buffer_load_dwordx4 v14, s[16:19], s44 offen lds
L_x5_6:
    s_add_u32 m0, s46, 86016
    s_cmp_eq_u32 s41, 0
    s_cselect_b32 s50, s47, s50
    s_cmp_eq_u32 s50, 0
    s_cselect_b32 s51, 1, 0
    s_mov_b32 s52, 0
    v_lshrrev_b32 v224, 5, v2
    v_bfe_u32 v220, v2, 2, 2
    buffer_load_dwordx4 v10, s[16:19], s44 offen lds
    s_add_u32 m0, s46, 90112
    v_lshl_add_u32 v224, v224, 2, v220
    v_lshlrev_b32 v224, 6, v224
    v_and_b32 v220, 1, v5
    v_lshl_add_u32 v224, v220, 5, v224
    v_and_b32 v220, 3, v2
    v_lshl_add_u32 v224, v220, 3, v224
    buffer_load_dwordx4 v11, s[16:19], s44 offen lds
    s_add_u32 m0, s46, 94208
    s_lshl_b32 s41, s3, 12
    s_add_u32 s41, s41, 131072
    v_add_u32 v224, s41, v224
    v_and_b32 v220, 4, v2
    v_lshlrev_b32 v220, 2, v220
    v_lshrrev_b32 v221, 1, v2
    buffer_load_dwordx4 v12, s[16:19], s44 offen lds
    s_add_u32 m0, s46, 98304
    v_and_b32 v221, 12, v221
    v_and_b32 v222, 3, v2
    v_or_b32 v220, v220, v221
    v_or_b32 v220, v220, v222
    v_and_b32 v221, 32, v2
    v_lshl_add_u32 v221, v220, 6, v221
    buffer_load_dwordx4 v13, s[16:19], s44 offen lds
    s_add_u32 m0, s46, 104448
    v_add_u32 v225, 2048, v221
    v_sub_u32 v226, 4064, v221
    v_and_b32 v222, 1, v2
    v_mul_u32_u24 v221, 48, v222
    v_add_u32 v229, 64, v225
    buffer_load_dwordx4 v16, s[20:23], s45 offen lds
    s_add_u32 m0, s46, 108544
    v_sub_u32 v229, v229, v221
    v_sub_u32 v225, v225, v221
    v_mul_u32_u24 v221, 80, v222
    v_subrev_u32 v230, 64, v226
    v_add_u32 v230, v230, v221
    v_add_u32 v226, v226, v221
    buffer_load_dwordx4 v17, s[20:23], s45 offen lds
    s_add_u32 m0, s46, 112640
    v_add_u32 v220, 1, v220
    v_and_b32 v221, 12, v220
    v_lshlrev_b32 v221, 1, v221
    v_lshrrev_b32 v222, 2, v220
    v_and_b32 v222, 4, v222
    v_and_b32 v220, 3, v220
    buffer_load_dwordx4 v18, s[20:23], s45 offen lds
    s_add_u32 m0, s46, 116736
    v_or_b32 v220, v220, v221
    v_or_b32 v220, v220, v222
    v_add_u32 v221, 32, v2
    v_cmp_gt_u32 vcc, 32, v2
    s_nop 1
    v_cndmask_b32 v220, v220, v221, vcc
    v_lshlrev_b32 v227, 2, v220
    buffer_load_dwordx4 v19, s[20:23], s45 offen lds
    v_mov_b32 v9, 0
    buffer_load_dwordx4 v[124:127], v9, s[12:15], 0 offen sc1
    s_waitcnt vmcnt(9)
    s_barrier
    s_add_u32 m0, s46, 120832
    s_nop 0
    buffer_load_dwordx4 v20, s[20:23], s45 offen lds
    s_add_u32 m0, s46, 124928
    s_nop 0
    buffer_load_dwordx4 v21, s[20:23], s45 offen lds
    s_add_u32 s44, s44, 128
    s_and_b32 s44, s44, 2047
    s_add_u32 s45, s45, 393216
    s_cmp_ge_u32 s45, 0x600000
    s_cselect_b32 s45, 0, s45
    s_add_u32 m0, s46, 16384
    s_cmp_ge_u32 s3, 2
    s_cbranch_scc1 L_x5_7
    buffer_load_dwordx4 v14, s[16:19], s44 offen lds
L_x5_7:
    s_add_u32 m0, s46, 0
    s_nop 0
    buffer_load_dwordx4 v10, s[16:19], s44 offen lds
    s_add_u32 m0, s46, 4096
    s_nop 0
    buffer_load_dwordx4 v11, s[16:19], s44 offen lds
    s_add_u32 m0, s46, 8192
    s_nop 0
    buffer_load_dwordx4 v12, s[16:19], s44 offen lds
    s_add_u32 m0, s46, 12288
    s_nop 0
    buffer_load_dwordx4 v13, s[16:19], s44 offen lds
    s_add_u32 m0, s46, 18432
    s_nop 0
    buffer_load_dwordx4 v16, s[20:23], s45 offen lds
    s_add_u32 m0, s46, 22528
    s_nop 0
    buffer_load_dwordx4 v17, s[20:23], s45 offen lds
    s_add_u32 m0, s46, 26624
    s_nop 0
    buffer_load_dwordx4 v18, s[20:23], s45 offen lds
    s_add_u32 m0, s46, 30720
    s_nop 0
    buffer_load_dwordx4 v19, s[20:23], s45 offen lds
    s_add_u32 m0, s46, 34816
    s_nop 0
    buffer_load_dwordx4 v20, s[20:23], s45 offen lds
    s_cmp_lg_u32 s57, 0
    s_cbranch_scc1 L_nos_18
    buffer_store_dwordx4 v[200:203], v231, s[36:39], s56 offen sc1
    s_add_u32 s56, s56, 0x40000
    buffer_store_dwordx4 v[204:207], v231, s[36:39], s56 offen sc1
    s_add_u32 s56, s56, 0x40000
    buffer_store_dwordx4 v[208:211], v231, s[36:39], s56 offen sc1
    s_add_u32 s56, s56, 0x40000
    buffer_store_dwordx4 v[212:215], v231, s[36:39], s56 offen sc1
    s_add_u32 s56, s56, 0x40000
L_nos_18:
    s_waitcnt vmcnt(9)
    s_barrier
    s_add_u32 m0, s46, 38912
    s_nop 0
    buffer_load_dwordx4 v21, s[20:23], s45 offen lds
    s_add_u32 s44, s44, 128
    s_and_b32 s44, s44, 2047
    s_add_u32 s45, s45, 393216
    s_cmp_ge_u32 s45, 0x600000
    s_cselect_b32 s45, 0, s45
    s_add_u32 m0, s46, 59392
    s_cmp_ge_u32 s3, 2
    s_cbranch_scc1 L_x5_8
    buffer_load_dwordx4 v14, s[16:19], s44 offen lds
L_x5_8:
    s_add_u32 m0, s46, 43008
    s_nop 0
    buffer_load_dwordx4 v10, s[16:19], s44 offen lds
    s_add_u32 m0, s46, 47104
    s_nop 0
    buffer_load_dwordx4 v11, s[16:19], s44 offen lds
    s_add_u32 m0, s46, 51200
    s_nop 0
    buffer_load_dwordx4 v12, s[16:19], s44 offen lds
    s_add_u32 m0, s46, 55296
    s_nop 0
    buffer_load_dwordx4 v13, s[16:19], s44 offen lds
    s_add_u32 m0, s46, 61440
    s_nop 0
    buffer_load_dwordx4 v16, s[20:23], s45 offen lds
    s_add_u32 m0, s46, 65536
    s_nop 0
    buffer_load_dwordx4 v17, s[20:23], s45 offen lds
    s_add_u32 m0, s46, 69632
    s_nop 0
    buffer_load_dwordx4 v18, s[20:23], s45 offen lds
    s_add_u32 m0, s46, 73728
    s_nop 0
    buffer_load_dwordx4 v19, s[20:23], s45 offen lds
    s_add_u32 m0, s46, 77824
    s_nop 0
    buffer_load_dwordx4 v20, s[20:23], s45 offen lds
    s_add_u32 m0, s46, 81920
    s_nop 0
    buffer_load_dwordx4 v21, s[20:23], s45 offen lds
    s_add_u32 s44, s44, 128
    s_and_b32 s44, s44, 2047
    s_add_u32 s45, s45, 393216
    s_cmp_ge_u32 s45, 0x600000
    s_cselect_b32 s45, 0, s45
    s_cmp_lg_u32 s57, 1
    s_cbranch_scc1 L_nos_19
    buffer_store_dwordx4 v[200:203], v231, s[36:39], s56 offen sc1
    s_add_u32 s56, s56, 0x40000
    buffer_store_dwordx4 v[204:207], v231, s[36:39], s56 offen sc1
    s_add_u32 s56, s56, 0x40000
    buffer_store_dwordx4 v[208:211], v231, s[36:39], s56 offen sc1
    s_add_u32 s56, s56, 0x40000
    buffer_store_dwordx4 v[212:215], v231, s[36:39], s56 offen sc1
    s_add_u32 s56, s56, 0x40000
L_nos_19:
    s_mov_b32 s47, 1048576
    s_waitcnt vmcnt(22)
L_poll_20:
    v_and_b32 v128, v124, v125
    v_and_b32 v129, v126, v127
    v_or_b32 v130, v124, v125
    v_or3_b32 v130, v130, v126, v127
    v_and_b32 v128, v128, v129
    v_cmp_ne_u32 vcc, 1, v128
    v_cmp_ne_u32 s[48:49], 1, v130
    s_nop 0
    s_or_b64 vcc, vcc, s[48:49]
    s_cbranch_scc0 L_pdone_21
    s_sleep 8
    buffer_load_dwordx4 v[124:127], v9, s[12:15], 0 offen sc1
    s_sub_u32 s47, s47, 1
    s_cmp_lg_u32 s47, 0
    s_waitcnt vmcnt(0)
    s_cbranch_scc1 L_poll_20
L_pdone_21:
    s_waitcnt vmcnt(10)
    s_barrier
    s_add_u32 m0, s46, 102400
    s_cmp_ge_u32 s3, 2
    s_cbranch_scc1 L_x5_9
    buffer_load_dwordx4 v14, s[16:19], s44 offen lds
L_x5_9:
    s_add_u32 m0, s46, 86016
    s_nop 0
    buffer_load_dwordx4 v10, s[16:19], s44 offen lds
    s_add_u32 m0, s46, 90112
    s_nop 0
    buffer_load_dwordx4 v11, s[16:19], s44 offen lds
    s_add_u32 m0, s46, 94208
    s_nop 0
    buffer_load_dwordx4 v12, s[16:19], s44 offen lds
    s_add_u32 m0, s46, 98304
    s_nop 0
    buffer_load_dwordx4 v13, s[16:19], s44 offen lds
    s_add_u32 m0, s46, 104448
    s_nop 0
    buffer_load_dwordx4 v16, s[20:23], s45 offen lds
    s_add_u32 m0, s46, 108544
    s_nop 0
    buffer_load_dwordx4 v17, s[20:23], s45 offen lds
    s_add_u32 m0, s46, 112640
    s_nop 0
    buffer_load_dwordx4 v18, s[20:23], s45 offen lds
    s_add_u32 m0, s46, 116736
    s_nop 0
    buffer_load_dwordx4 v19, s[20:23], s45 offen lds
    s_add_u32 m0, s46, 120832
    s_nop 0
    buffer_load_dwordx4 v20, s[20:23], s45 offen lds
    s_add_u32 m0, s46, 124928
    s_nop 0
    buffer_load_dwordx4 v21, s[20:23], s45 offen lds
    s_add_u32 s44, s44, 128
    s_and_b32 s44, s44, 2047
    s_add_u32 s45, s45, 393216
    s_cmp_ge_u32 s45, 0x600000
    s_cselect_b32 s45, 0, s45
    s_cmp_lg_u32 s57, 2
    s_cbranch_scc1 L_nos_22
    buffer_store_dwordx4 v[200:203], v231, s[36:39], s56 offen sc1
    s_add_u32 s56, s56, 0x40000
    buffer_store_dwordx4 v[204:207], v231, s[36:39], s56 offen sc1
    s_add_u32 s56, s56, 0x40000
    buffer_store_dwordx4 v[208:211], v231, s[36:39], s56 offen sc1
    s_add_u32 s56, s56, 0x40000
    buffer_store_dwordx4 v[212:215], v231, s[36:39], s56 offen sc1
    s_add_u32 s56, s56, 0x40000
L_nos_22:
    s_waitcnt vmcnt(10)
    s_barrier
    s_lshl_b32 s41, s3, 4
    s_add_u32 s41, s41, s57
    s_cmp_gt_u32 s41, 0
    s_cbranch_scc1 L_novf_23
    s_lshr_b32 s41, s2, 3
    s_lshl_b32 s41, s41, 7
    s_and_b32 s42, s2, 7
    s_lshl_b32 s42, s42, 2
    s_add_u32 s41, s41, s42
    s_add_u32 s41, s41, 8454144
    v_mov_b32 v6, 0
    v_mov_b32 v7, 1
    s_mov_b64 exec, 1
    buffer_store_dword v7, v6, s[36:39], s41 offen sc1
    s_mov_b64 exec, -1
L_novf_23:
    s_add_u32 m0, s46, 16384
    s_cmp_ge_u32 s3, 2
    s_cbranch_scc1 L_x5_10
    buffer_load_dwordx4 v14, s[16:19], s44 offen lds
L_x5_10:
    s_add_u32 m0, s46, 0
    s_nop 0
    buffer_load_dwordx4 v10, s[16:19], s44 offen lds
    s_add_u32 m0, s46, 4096
    s_nop 0
    buffer_load_dwordx4 v11, s[16:19], s44 offen lds
    s_add_u32 m0, s46, 8192
    s_nop 0
    buffer_load_dwordx4 v12, s[16:19], s44 offen lds
    s_add_u32 m0, s46, 12288
    s_nop 0
    buffer_load_dwordx4 v13, s[16:19], s44 offen lds
    s_add_u32 m0, s46, 18432
    s_nop 0
    buffer_load_dwordx4 v16, s[20:23], s45 offen lds
    s_add_u32 m0, s46, 22528
    s_nop 0
    buffer_load_dwordx4 v17, s[20:23], s45 offen lds
    s_add_u32 m0, s46, 26624
    s_nop 0
    buffer_load_dwordx4 v18, s[20:23], s45 offen lds
    s_add_u32 m0, s46, 30720
    s_nop 0
    buffer_load_dwordx4 v19, s[20:23], s45 offen lds
    s_add_u32 m0, s46, 34816
    s_nop 0
    buffer_load_dwordx4 v20, s[20:23], s45 offen lds
    s_add_u32 m0, s46, 38912
    s_nop 0
    buffer_load_dwordx4 v21, s[20:23], s45 offen lds
    s_add_u32 s44, s44, 128
    s_and_b32 s44, s44, 2047
    s_add_u32 s45, s45, 393216
    s_cmp_ge_u32 s45, 0x600000
    s_cselect_b32 s45, 0, s45
    s_cmp_lg_u32 s57, 3
    s_cbranch_scc1 L_nos_24
    buffer_store_dwordx4 v[200:203], v231, s[36:39], s56 offen sc1
    s_add_u32 s56, s56, 0x40000
    buffer_store_dwordx4 v[204:207], v231, s[36:39], s56 offen sc1
    s_add_u32 s56, s56, 0x40000
    buffer_store_dwordx4 v[208:211], v231, s[36:39], s56 offen sc1
    s_add_u32 s56, s56, 0x40000
    buffer_store_dwordx4 v[212:215], v231, s[36:39], s56 offen sc1
    s_add_u32 s56, s56, 0x40000
L_nos_24:
    s_waitcnt vmcnt(10)
    s_barrier
    s_lshl_b32 s41, s3, 4
    s_add_u32 s41, s41, s57
    s_cmp_lg_u32 s41, 1
    s_cbranch_scc1 L_novf_25
    s_lshr_b32 s41, s2, 3
    s_lshl_b32 s41, s41, 7
    s_and_b32 s42, s2, 7
    s_lshl_b32 s42, s42, 2
    s_add_u32 s41, s41, s42
    s_add_u32 s41, s41, 8454144
    v_mov_b32 v6, 0
    v_mov_b32 v7, 1
    s_mov_b64 exec, 1
    buffer_store_dword v7, v6, s[36:39], s41 offen sc1
    s_mov_b64 exec, -1
L_novf_25:
    s_add_u32 m0, s46, 59392
    s_cmp_ge_u32 s3, 2
    s_cbranch_scc1 L_x5_11
    buffer_load_dwordx4 v14, s[16:19], s44 offen lds
L_x5_11:
    s_add_u32 m0, s46, 43008
    s_nop 0
    buffer_load_dwordx4 v10, s[16:19], s44 offen lds
    s_add_u32 m0, s46, 47104
    s_nop 0
    buffer_load_dwordx4 v11, s[16:19], s44 offen lds
    s_add_u32 m0, s46, 51200
    s_nop 0
    buffer_load_dwordx4 v12, s[16:19], s44 offen lds
    s_add_u32 m0, s46, 55296
    s_nop 0
    buffer_load_dwordx4 v13, s[16:19], s44 offen lds
    s_add_u32 m0, s46, 61440
    s_nop 0
    buffer_load_dwordx4 v16, s[20:23], s45 offen lds
    s_add_u32 m0, s46, 65536
    s_nop 0
    buffer_load_dwordx4 v17, s[20:23], s45 offen lds
    s_add_u32 m0, s46, 69632
    s_nop 0
    buffer_load_dwordx4 v18, s[20:23], s45 offen lds
    s_add_u32 m0, s46, 73728
    s_nop 0
    buffer_load_dwordx4 v19, s[20:23], s45 offen lds
    s_add_u32 m0, s46, 77824
    s_nop 0
    buffer_load_dwordx4 v20, s[20:23], s45 offen lds
    s_add_u32 m0, s46, 81920
    s_nop 0
    buffer_load_dwordx4 v21, s[20:23], s45 offen lds
    s_add_u32 s44, s44, 128
    s_and_b32 s44, s44, 2047
    s_add_u32 s45, s45, 393216
    s_cmp_ge_u32 s45, 0x600000
    s_cselect_b32 s45, 0, s45
    s_waitcnt vmcnt(10)
    s_barrier
    s_lshl_b32 s41, s3, 4
    s_add_u32 s41, s41, s57
    s_cmp_lg_u32 s41, 2
    s_cbranch_scc1 L_novf_26
    s_lshr_b32 s41, s2, 3
    s_lshl_b32 s41, s41, 7
    s_and_b32 s42, s2, 7
    s_lshl_b32 s42, s42, 2
    s_add_u32 s41, s41, s42
    s_add_u32 s41, s41, 8454144
    v_mov_b32 v6, 0
    v_mov_b32 v7, 1
    s_mov_b64 exec, 1
    buffer_store_dword v7, v6, s[36:39], s41 offen sc1
    s_mov_b64 exec, -1
L_novf_26:
    s_add_u32 m0, s46, 102400
    s_cmp_ge_u32 s3, 2
    s_cbranch_scc1 L_x5_12
    buffer_load_dwordx4 v14, s[16:19], s44 offen lds
L_x5_12:
    s_add_u32 m0, s46, 86016
    s_nop 0
    buffer_load_dwordx4 v10, s[16:19], s44 offen lds
    s_add_u32 m0, s46, 90112
    s_nop 0
    buffer_load_dwordx4 v11, s[16:19], s44 offen lds
    s_add_u32 m0, s46, 94208
    s_nop 0
    buffer_load_dwordx4 v12, s[16:19], s44 offen lds
    s_add_u32 m0, s46, 98304
    s_nop 0
    buffer_load_dwordx4 v13, s[16:19], s44 offen lds
    s_add_u32 m0, s46, 104448
    s_nop 0
    buffer_load_dwordx4 v16, s[20:23], s45 offen lds
    s_add_u32 m0, s46, 108544
    s_nop 0
    buffer_load_dwordx4 v17, s[20:23], s45 offen lds
    s_add_u32 m0, s46, 112640
    s_nop 0
    buffer_load_dwordx4 v18, s[20:23], s45 offen lds
    s_add_u32 m0, s46, 116736
    s_nop 0
    buffer_load_dwordx4 v19, s[20:23], s45 offen lds
    s_add_u32 m0, s46, 120832
    s_nop 0
    buffer_load_dwordx4 v20, s[20:23], s45 offen lds
    s_add_u32 m0, s46, 124928
    s_nop 0
    buffer_load_dwordx4 v21, s[20:23], s45 offen lds
    s_add_u32 s44, s44, 128
    s_and_b32 s44, s44, 2047
    s_add_u32 s45, s45, 393216
    s_cmp_ge_u32 s45, 0x600000
    s_cselect_b32 s45, 0, s45
    s_waitcnt vmcnt(10)
    s_barrier
    s_lshl_b32 s41, s3, 4
    s_add_u32 s41, s41, s57
    s_cmp_lg_u32 s41, 3
    s_cbranch_scc1 L_novf_27
    s_lshr_b32 s41, s2, 3
    s_lshl_b32 s41, s41, 7
    s_and_b32 s42, s2, 7
    s_lshl_b32 s42, s42, 2
    s_add_u32 s41, s41, s42
    s_add_u32 s41, s41, 8454144
    v_mov_b32 v6, 0
    v_mov_b32 v7, 1
    s_mov_b64 exec, 1
    buffer_store_dword v7, v6, s[36:39], s41 offen sc1
    s_mov_b64 exec, -1
L_novf_27:
    s_add_u32 m0, s46, 16384
    s_cmp_ge_u32 s3, 2
    s_cbranch_scc1 L_x5_13
    buffer_load_dwordx4 v14, s[16:19], s44 offen lds
L_x5_13:
    s_add_u32 m0, s46, 0
    s_nop 0
    buffer_load_dwordx4 v10, s[16:19], s44 offen lds
    s_add_u32 m0, s46, 4096
    s_nop 0
    buffer_load_dwordx4 v11, s[16:19], s44 offen lds
    s_add_u32 m0, s46, 8192
    s_nop 0
    buffer_load_dwordx4 v12, s[16:19], s44 offen lds
    s_add_u32 m0, s46, 12288
    s_nop 0
    buffer_load_dwordx4 v13, s[16:19], s44 offen lds
    s_add_u32 m0, s46, 18432
    s_nop 0
    buffer_load_dwordx4 v16, s[20:23], s45 offen lds
    s_add_u32 m0, s46, 22528
    s_nop 0
    buffer_load_dwordx4 v17, s[20:23], s45 offen lds
    s_add_u32 m0, s46, 26624
    s_nop 0
    buffer_load_dwordx4 v18, s[20:23], s45 offen lds
    s_add_u32 m0, s46, 30720
    s_nop 0
    buffer_load_dwordx4 v19, s[20:23], s45 offen lds
    s_add_u32 m0, s46, 34816
    s_nop 0
    buffer_load_dwordx4 v20, s[20:23], s45 offen lds
    s_add_u32 m0, s46, 38912
    s_nop 0
    buffer_load_dwordx4 v21, s[20:23], s45 offen lds
    s_add_u32 s44, s44, 128
    s_and_b32 s44, s44, 2047
    s_add_u32 s45, s45, 393216
    s_cmp_ge_u32 s45, 0x600000
    s_cselect_b32 s45, 0, s45
    s_waitcnt vmcnt(10)
    s_barrier
    s_add_u32 m0, s46, 59392
    s_cmp_ge_u32 s3, 2
    s_cbranch_scc1 L_x5_14
    buffer_load_dwordx4 v14, s[16:19], s44 offen lds
L_x5_14:
    s_add_u32 m0, s46, 43008
    s_nop 0
    buffer_load_dwordx4 v10, s[16:19], s44 offen lds
    s_add_u32 m0, s46, 47104
    s_nop 0
    buffer_load_dwordx4 v11, s[16:19], s44 offen lds
    s_add_u32 m0, s46, 51200
    s_nop 0
    buffer_load_dwordx4 v12, s[16:19], s44 offen lds
    s_add_u32 m0, s46, 55296
    s_nop 0
    buffer_load_dwordx4 v13, s[16:19], s44 offen lds
    s_add_u32 m0, s46, 61440
    s_nop 0
    buffer_load_dwordx4 v16, s[20:23], s45 offen lds
    s_add_u32 m0, s46, 65536
    s_nop 0
    buffer_load_dwordx4 v17, s[20:23], s45 offen lds
    s_add_u32 m0, s46, 69632
    s_nop 0
    buffer_load_dwordx4 v18, s[20:23], s45 offen lds
    s_add_u32 m0, s46, 73728
    s_nop 0
    buffer_load_dwordx4 v19, s[20:23], s45 offen lds
    s_add_u32 m0, s46, 77824
    s_nop 0
    buffer_load_dwordx4 v20, s[20:23], s45 offen lds
    s_add_u32 m0, s46, 81920
    s_nop 0
    buffer_load_dwordx4 v21, s[20:23], s45 offen lds
    s_add_u32 s44, s44, 128
    s_and_b32 s44, s44, 2047
    s_add_u32 s45, s45, 393216
    s_cmp_ge_u32 s45, 0x600000
    s_cselect_b32 s45, 0, s45
    s_waitcnt vmcnt(10)
    s_barrier
    s_add_u32 m0, s46, 102400
    s_cmp_ge_u32 s3, 2
    s_cbranch_scc1 L_x5_15
    buffer_load_dwordx4 v14, s[16:19], s44 offen lds
L_x5_15:
    s_add_u32 m0, s46, 86016
    s_nop 0
    buffer_load_dwordx4 v10, s[16:19], s44 offen lds
    s_add_u32 m0, s46, 90112
    s_nop 0
    buffer_load_dwordx4 v11, s[16:19], s44 offen lds
    s_add_u32 m0, s46, 94208
    s_nop 0
    buffer_load_dwordx4 v12, s[16:19], s44 offen lds
    s_add_u32 m0, s46, 98304
    s_nop 0
    buffer_load_dwordx4 v13, s[16:19], s44 offen lds
    s_add_u32 m0, s46, 104448
    s_nop 0
    buffer_load_dwordx4 v16, s[20:23], s45 offen lds
    s_add_u32 m0, s46, 108544
    s_nop 0
    buffer_load_dwordx4 v17, s[20:23], s45 offen lds
    s_add_u32 m0, s46, 112640
    s_nop 0
    buffer_load_dwordx4 v18, s[20:23], s45 offen lds
    s_add_u32 m0, s46, 116736
    s_nop 0
    buffer_load_dwordx4 v19, s[20:23], s45 offen lds
    s_add_u32 m0, s46, 120832
    s_nop 0
    buffer_load_dwordx4 v20, s[20:23], s45 offen lds
    s_add_u32 m0, s46, 124928
    s_nop 0
    buffer_load_dwordx4 v21, s[20:23], s45 offen lds
    s_add_u32 s44, s44, 128
    s_and_b32 s44, s44, 2047
    s_add_u32 s45, s45, 393216
    s_cmp_ge_u32 s45, 0x600000
    s_cselect_b32 s45, 0, s45
    s_waitcnt vmcnt(10)
    s_barrier
    s_add_u32 m0, s46, 16384
    s_cmp_ge_u32 s3, 2
    s_cbranch_scc1 L_x5_16
    buffer_load_dwordx4 v14, s[16:19], s44 offen lds
L_x5_16:
    s_add_u32 m0, s46, 0
    s_nop 0
    buffer_load_dwordx4 v10, s[16:19], s44 offen lds
    s_add_u32 m0, s46, 4096
    s_nop 0
    buffer_load_dwordx4 v11, s[16:19], s44 offen lds
    s_add_u32 m0, s46, 8192
    s_nop 0
    buffer_load_dwordx4 v12, s[16:19], s44 offen lds
    s_add_u32 m0, s46, 12288
    s_nop 0
    buffer_load_dwordx4 v13, s[16:19], s44 offen lds
    s_add_u32 m0, s46, 18432
    s_nop 0
    buffer_load_dwordx4 v16, s[20:23], s45 offen lds
    s_add_u32 m0, s46, 22528
    s_nop 0
    buffer_load_dwordx4 v17, s[20:23], s45 offen lds
    s_add_u32 m0, s46, 26624
    s_nop 0
    buffer_load_dwordx4 v18, s[20:23], s45 offen lds
    s_add_u32 m0, s46, 30720
    s_nop 0
    buffer_load_dwordx4 v19, s[20:23], s45 offen lds
    s_add_u32 m0, s46, 34816
    s_nop 0
    buffer_load_dwordx4 v20, s[20:23], s45 offen lds
    s_add_u32 m0, s46, 38912
    s_nop 0
    buffer_load_dwordx4 v21, s[20:23], s45 offen lds
    s_add_u32 s44, s44, 128
    s_and_b32 s44, s44, 2047
    s_add_u32 s45, s45, 393216
    s_cmp_ge_u32 s45, 0x600000
    s_cselect_b32 s45, 0, s45
    s_waitcnt vmcnt(10)
    s_barrier
    s_lshl_b32 s53, s10, 2
    s_add_u32 s53, s53, s3
    s_add_u32 s47, s53, 42
    s_and_b32 s47, s47, 63
    s_add_u32 s48, s3, 42
    s_and_b32 s48, s48, 64
    s_or_b32 s47, s47, s48
    s_add_u32 m0, s46, 43008
    s_lshl_b32 s47, s47, 14
    buffer_load_dwordx4 v23, s[24:27], s47 offen  lds
    s_add_u32 s47, s53, 46
    s_and_b32 s47, s47, 63
    s_add_u32 s48, s3, 46
    s_and_b32 s48, s48, 64
    s_or_b32 s47, s47, s48
    s_add_u32 m0, s46, 47104
    s_lshl_b32 s47, s47, 14
    buffer_load_dwordx4 v23, s[24:27], s47 offen  lds
    s_add_u32 s47, s53, 50
    s_and_b32 s47, s47, 63
    s_add_u32 s48, s3, 50
    s_and_b32 s48, s48, 64
    s_or_b32 s47, s47, s48
    s_add_u32 m0, s46, 51200
    s_lshl_b32 s47, s47, 14
    buffer_load_dwordx4 v23, s[24:27], s47 offen  lds
    s_add_u32 s47, s53, 54
    s_and_b32 s47, s47, 63
    s_add_u32 s48, s3, 54
    s_and_b32 s48, s48, 64
    s_or_b32 s47, s47, s48
    s_add_u32 m0, s46, 55296
    s_lshl_b32 s47, s47, 14
    buffer_load_dwordx4 v23, s[24:27], s47 offen  lds
    s_add_u32 s47, s53, 58
    s_and_b32 s47, s47, 63
    s_add_u32 s48, s3, 58
    s_and_b32 s48, s48, 64
    s_or_b32 s47, s47, s48
    s_add_u32 m0, s46, 59392
    s_lshl_b32 s47, s47, 14
    buffer_load_dwordx4 v23, s[24:27], s47 offen  lds
    s_add_u32 s47, s53, 62
    s_and_b32 s47, s47, 63
    s_add_u32 s48, s3, 62
    s_and_b32 s48, s48, 64
    s_or_b32 s47, s47, s48
    s_add_u32 m0, s46, 63488
    s_lshl_b32 s47, s47, 14
    buffer_load_dwordx4 v23, s[24:27], s47 offen  lds
    s_add_u32 s47, s53, 66
    s_and_b32 s47, s47, 63
    s_add_u32 s48, s3, 66
    s_and_b32 s48, s48, 64
    s_or_b32 s47, s47, s48
    s_add_u32 m0, s46, 67584
    s_lshl_b32 s47, s47, 14
    buffer_load_dwordx4 v23, s[24:27], s47 offen  lds
    s_add_u32 s47, s53, 70
    s_and_b32 s47, s47, 63
    s_add_u32 s48, s3, 70
    s_and_b32 s48, s48, 64
    s_or_b32 s47, s47, s48
    s_add_u32 m0, s46, 71680
    s_lshl_b32 s47, s47, 14
    buffer_load_dwordx4 v23, s[24:27], s47 offen  lds
    s_add_u32 s47, s53, 74
    s_and_b32 s47, s47, 63
    s_add_u32 s48, s3, 74
    s_and_b32 s48, s48, 64
    s_or_b32 s47, s47, s48
    s_add_u32 m0, s46, 75776
    s_lshl_b32 s47, s47, 14
    buffer_load_dwordx4 v23, s[24:27], s47 offen  lds
    s_add_u32 s47, s53, 78
    s_and_b32 s47, s47, 63
    s_add_u32 s48, s3, 78
    s_and_b32 s48, s48, 64
    s_or_b32 s47, s47, s48
    s_add_u32 m0, s46, 79872
    s_lshl_b32 s47, s47, 14
    buffer_load_dwordx4 v23, s[24:27], s47 offen  lds
    s_waitcnt vmcnt(10)
    s_barrier
    s_add_u32 s47, s53, 82
    s_and_b32 s47, s47, 63
    s_add_u32 s48, s3, 82
    s_and_b32 s48, s48, 64
    s_or_b32 s47, s47, s48
    s_add_u32 m0, s46, 83968
    s_lshl_b32 s47, s47, 14
    buffer_load_dwordx4 v23, s[24:27], s47 offen  lds
    s_add_u32 s47, s53, 86
    s_and_b32 s47, s47, 63
    s_add_u32 s48, s3, 86
    s_and_b32 s48, s48, 64
    s_or_b32 s47, s47, s48
    s_add_u32 m0, s46, 88064
    s_lshl_b32 s47, s47, 14
    buffer_load_dwordx4 v23, s[24:27], s47 offen  lds
    s_add_u32 s47, s53, 90
    s_and_b32 s47, s47, 63
    s_add_u32 s48, s3, 90
    s_and_b32 s48, s48, 64
    s_or_b32 s47, s47, s48
    s_add_u32 m0, s46, 92160
    s_lshl_b32 s47, s47, 14
    buffer_load_dwordx4 v23, s[24:27], s47 offen  lds
    s_add_u32 s47, s53, 94
    s_and_b32 s47, s47, 63
    s_add_u32 s48, s3, 94
    s_and_b32 s48, s48, 64
    s_or_b32 s47, s47, s48
    s_add_u32 m0, s46, 96256
    s_lshl_b32 s47, s47, 14
    buffer_load_dwordx4 v23, s[24:27], s47 offen  lds
    s_add_u32 s47, s53, 98
    s_and_b32 s47, s47, 63
    s_add_u32 s48, s3, 98
    s_and_b32 s48, s48, 64
    s_or_b32 s47, s47, s48
    s_add_u32 m0, s46, 100352
    s_lshl_b32 s47, s47, 14
    buffer_load_dwordx4 v23, s[24:27], s47 offen  lds
    s_add_u32 s47, s53, 102
    s_and_b32 s47, s47, 63
    s_add_u32 s48, s3, 102
    s_and_b32 s48, s48, 64
    s_or_b32 s47, s47, s48
    s_add_u32 m0, s46, 104448
    s_lshl_b32 s47, s47, 14
    buffer_load_dwordx4 v23, s[24:27], s47 offen  lds
    s_add_u32 s47, s53, 106
    s_and_b32 s47, s47, 63
    s_add_u32 s48, s3, 106
    s_and_b32 s48, s48, 64
    s_or_b32 s47, s47, s48
    s_add_u32 m0, s46, 108544
    s_lshl_b32 s47, s47, 14
    buffer_load_dwordx4 v23, s[24:27], s47 offen  lds
    s_add_u32 s47, s53, 110
    s_and_b32 s47, s47, 63
    s_add_u32 s48, s3, 110
    s_and_b32 s48, s48, 64
    s_or_b32 s47, s47, s48
    s_add_u32 m0, s46, 112640
    s_lshl_b32 s47, s47, 14
    buffer_load_dwordx4 v23, s[24:27], s47 offen  lds
    s_add_u32 s47, s53, 114
    s_and_b32 s47, s47, 63
    s_add_u32 s48, s3, 114
    s_and_b32 s48, s48, 64
    s_or_b32 s47, s47, s48
    s_add_u32 m0, s46, 116736
    s_lshl_b32 s47, s47, 14
    buffer_load_dwordx4 v23, s[24:27], s47 offen  lds
    s_add_u32 s47, s53, 118
    s_and_b32 s47, s47, 63
    s_add_u32 s48, s3, 118
    s_and_b32 s48, s48, 64
    s_or_b32 s47, s47, s48
    s_add_u32 m0, s46, 120832
    s_lshl_b32 s47, s47, 14
    buffer_load_dwordx4 v23, s[24:27], s47 offen  lds
    s_add_u32 s47, s53, 122
    s_and_b32 s47, s47, 63
    s_add_u32 s48, s3, 122
    s_and_b32 s48, s48, 64
    s_or_b32 s47, s47, s48
    s_add_u32 m0, s46, 124928
    s_lshl_b32 s47, s47, 14
    buffer_load_dwordx4 v23, s[24:27], s47 offen  lds
    s_cmp_ge_u32 s3, 2
    s_cbranch_scc1 L_wox_28
    s_add_u32 s47, s53, 126
    s_and_b32 s47, s47, 63
    s_add_u32 s48, s3, 126
    s_and_b32 s48, s48, 64
    s_or_b32 s47, s47, s48
    s_add_u32 m0, s46, 129024
    s_lshl_b32 s47, s47, 14
    buffer_load_dwordx4 v23, s[24:27], s47 offen  lds
L_wox_28:
    v_mov_b32 v216, 162832
    v_lshrrev_b32 v9, 1, v2
    v_lshlrev_b32 v9, 7, v9
    v_and_b32 v7, 1, v2
    v_lshl_add_u32 v9, v7, 4, v9
    v_add_u32 v9, 8454144, v9
L_exw_29:
    ds_read_b128 v[220:223], v216
    s_waitcnt lgkmcnt(0)
    v_and_b32 v220, v220, v221
    v_and_b32 v222, v222, v223
    v_and_b32 v220, v220, v222
    s_nop 0
    v_readfirstlane_b32 s40, v220
    s_nop 0
    s_cmp_eq_u32 s40, 0
    s_cbranch_scc1 L_exw_29
    buffer_load_dwordx4 v[124:127], v9, s[36:39], 0 offen sc1
    s_add_u32 s47, s53, 0
    s_and_b32 s47, s47, 63
    s_add_u32 s48, s3, 0
    s_and_b32 s48, s48, 64
    s_or_b32 s47, s47, s48
    s_add_u32 m0, s46, 0
    s_lshl_b32 s47, s47, 14
    buffer_load_dwordx4 v23, s[24:27], s47 offen  lds
    s_add_u32 s47, s53, 4
    s_and_b32 s47, s47, 63
    s_add_u32 s48, s3, 4
    s_and_b32 s48, s48, 64
    s_or_b32 s47, s47, s48
    s_add_u32 m0, s46, 4096
    s_lshl_b32 s47, s47, 14
    buffer_load_dwordx4 v23, s[24:27], s47 offen  lds
    s_add_u32 s47, s53, 8
    s_and_b32 s47, s47, 63
    s_add_u32 s48, s3, 8
    s_and_b32 s48, s48, 64
    s_or_b32 s47, s47, s48
    s_add_u32 m0, s46, 8192
    s_lshl_b32 s47, s47, 14
    buffer_load_dwordx4 v23, s[24:27], s47 offen  lds
    s_add_u32 s47, s53, 12
    s_and_b32 s47, s47, 63
    s_add_u32 s48, s3, 12
    s_and_b32 s48, s48, 64
    s_or_b32 s47, s47, s48
    s_add_u32 m0, s46, 12288
    s_lshl_b32 s47, s47, 14
    buffer_load_dwordx4 v23, s[24:27], s47 offen  lds
    s_add_u32 s47, s53, 16
    s_and_b32 s47, s47, 63
    s_add_u32 s48, s3, 16
    s_and_b32 s48, s48, 64
    s_or_b32 s47, s47, s48
    s_add_u32 m0, s46, 16384
    s_lshl_b32 s47, s47, 14
    buffer_load_dwordx4 v23, s[24:27], s47 offen  lds
    s_add_u32 s47, s53, 20
    s_and_b32 s47, s47, 63
    s_add_u32 s48, s3, 20
    s_and_b32 s48, s48, 64
    s_or_b32 s47, s47, s48
    s_add_u32 m0, s46, 20480
    s_lshl_b32 s47, s47, 14
    buffer_load_dwordx4 v23, s[24:27], s47 offen  lds
    s_add_u32 s47, s53, 24
    s_and_b32 s47, s47, 63
    s_add_u32 s48, s3, 24
    s_and_b32 s48, s48, 64
    s_or_b32 s47, s47, s48
    s_add_u32 m0, s46, 24576
    s_lshl_b32 s47, s47, 14
    buffer_load_dwordx4 v23, s[24:27], s47 offen  lds
    s_add_u32 s47, s53, 28
    s_and_b32 s47, s47, 63
    s_add_u32 s48, s3, 28
    s_and_b32 s48, s48, 64
    s_or_b32 s47, s47, s48
    s_add_u32 m0, s46, 28672
    s_lshl_b32 s47, s47, 14
    buffer_load_dwordx4 v23, s[24:27], s47 offen  lds
    s_add_u32 s47, s53, 32
    s_and_b32 s47, s47, 63
    s_add_u32 s48, s3, 32
    s_and_b32 s48, s48, 64
    s_or_b32 s47, s47, s48
    s_add_u32 m0, s46, 32768
    s_lshl_b32 s47, s47, 14
    buffer_load_dwordx4 v23, s[24:27], s47 offen  lds
    s_add_u32 s47, s53, 36
    s_and_b32 s47, s47, 63
    s_add_u32 s48, s3, 36
    s_and_b32 s48, s48, 64
    s_or_b32 s47, s47, s48
    s_add_u32 m0, s46, 36864
    s_lshl_b32 s47, s47, 14
    buffer_load_dwordx4 v23, s[24:27], s47 offen  lds
    s_cmp_ge_u32 s3, 2
    s_cbranch_scc1 L_wox_30
    s_add_u32 s47, s53, 40
    s_and_b32 s47, s47, 63
    s_add_u32 s48, s3, 40
    s_and_b32 s48, s48, 64
    s_or_b32 s47, s47, s48
    s_add_u32 m0, s46, 40960
    s_lshl_b32 s47, s47, 14
    buffer_load_dwordx4 v23, s[24:27], s47 offen  lds
L_wox_30:
    s_waitcnt vmcnt(10)
    v_and_b32 v128, v124, v125
    v_and_b32 v129, v126, v127
    v_and_b32 v128, v128, v129
    v_cmp_ne_u32 vcc, 1, v128
    s_nop 0
    s_cmp_eq_u64 vcc, 0
    s_cbranch_scc0 L_vlate_31
    v_mov_b32 v216, 162852
    v_mov_b32 v217, 1
    ds_add_u32 v216, v217
    v_and_b32 v6, 15, v2
    v_lshlrev_b32 v6, 4, v6
    v_lshrrev_b32 v7, 5, v2
    v_lshl_add_u32 v6, v7, 8, v6
    v_and_b32 v7, 1, v5
    v_lshl_add_u32 v6, v7, 14, v6
    s_lshl_b32 s41, s4, 4
    s_add_u32 s41, s41, s9
    s_lshl_b32 s41, s41, 15
    s_lshl_b32 s42, s3, 9
    s_add_u32 s41, s41, s42
    s_add_u32 s41, s41, 4194304
    buffer_load_dwordx4 v[120:123], v6, s[36:39], s41 offen offset:0 sc1
    buffer_load_dwordx4 v[124:127], v6, s[36:39], s41 offen offset:2048 sc1
    s_add_u32 s41, s41, 4096
    buffer_load_dwordx4 v[128:131], v6, s[36:39], s41 offen offset:0 sc1
    buffer_load_dwordx4 v[132:135], v6, s[36:39], s41 offen offset:2048 sc1
    s_add_u32 s41, s41, 4096
    buffer_load_dwordx4 v[136:139], v6, s[36:39], s41 offen offset:0 sc1
    buffer_load_dwordx4 v[140:143], v6, s[36:39], s41 offen offset:2048 sc1
    s_add_u32 s41, s41, 4096
    buffer_load_dwordx4 v[144:147], v6, s[36:39], s41 offen offset:0 sc1
    buffer_load_dwordx4 v[148:151], v6, s[36:39], s41 offen offset:2048 sc1
    s_add_u32 s41, s41, 4096
    s_waitcnt vmcnt(8)
    v_mov_b32 v216, 162824
    v_mov_b32 v217, 1
    ds_add_u32 v216, v217
    s_branch L_vjoin_32
L_vlate_31:
    s_waitcnt vmcnt(0)
    v_mov_b32 v216, 162824
    v_mov_b32 v217, 1
    ds_add_u32 v216, v217
    s_cmp_lg_u32 s3, 0
    s_cbranch_scc1 L_voth_33
    s_mov_b32 s47, 1048576
    s_waitcnt vmcnt(0)
L_poll_34:
    v_and_b32 v128, v124, v125
    v_and_b32 v129, v126, v127
    v_or_b32 v130, v124, v125
    v_or3_b32 v130, v130, v126, v127
    v_and_b32 v128, v128, v129
    v_cmp_ne_u32 vcc, 1, v128
    v_cmp_ne_u32 s[48:49], 1, v130
    s_nop 0
    s_or_b64 vcc, vcc, s[48:49]
    s_cbranch_scc0 L_pdone_35
    s_sleep 8
    buffer_load_dwordx4 v[124:127], v9, s[36:39], 0 offen sc1
    s_sub_u32 s47, s47, 1
    s_cmp_lg_u32 s47, 0
    s_waitcnt vmcnt(0)
    s_cbranch_scc1 L_poll_34
L_pdone_35:
    v_mov_b32 v216, 162852
    v_mov_b32 v217, 1
    ds_add_u32 v216, v217
L_voth_33:
    v_mov_b32 v216, 162852
L_lw_36:
    ds_read_b32 v217, v216
    s_waitcnt lgkmcnt(0)
    v_readfirstlane_b32 s40, v217
    s_nop 0
    s_cmp_ge_u32 s40, 64
    s_cbranch_scc0 L_lw_36
    v_and_b32 v6, 15, v2
    v_lshlrev_b32 v6, 4, v6
    v_lshrrev_b32 v7, 5, v2
    v_lshl_add_u32 v6, v7, 8, v6
    v_and_b32 v7, 1, v5
    v_lshl_add_u32 v6, v7, 14, v6
    s_lshl_b32 s41, s4, 4
    s_add_u32 s41, s41, s9
    s_lshl_b32 s41, s41, 15
    s_lshl_b32 s42, s3, 9
    s_add_u32 s41, s41, s42
    s_add_u32 s41, s41, 4194304
    buffer_load_dwordx4 v[120:123], v6, s[36:39], s41 offen offset:0 sc1
    buffer_load_dwordx4 v[124:127], v6, s[36:39], s41 offen offset:2048 sc1
    s_add_u32 s41, s41, 4096
    buffer_load_dwordx4 v[128:131], v6, s[36:39], s41 offen offset:0 sc1
    buffer_load_dwordx4 v[132:135], v6, s[36:39], s41 offen offset:2048 sc1
    s_add_u32 s41, s41, 4096
    buffer_load_dwordx4 v[136:139], v6, s[36:39], s41 offen offset:0 sc1
    buffer_load_dwordx4 v[140:143], v6, s[36:39], s41 offen offset:2048 sc1
    s_add_u32 s41, s41, 4096
    buffer_load_dwordx4 v[144:147], v6, s[36:39], s41 offen offset:0 sc1
    buffer_load_dwordx4 v[148:151], v6, s[36:39], s41 offen offset:2048 sc1
    s_add_u32 s41, s41, 4096
L_vjoin_32:
    s_waitcnt vmcnt(0)
    s_mov_b32 s41, 0x05040100
    s_mov_b32 s42, 0x07060302
    v_perm_b32 v152, v124, v120, s41
    v_perm_b32 v153, v132, v128, s41
    v_perm_b32 v154, v140, v136, s41
    v_perm_b32 v155, v148, v144, s41
    v_perm_b32 v156, v124, v120, s42
    v_perm_b32 v157, v132, v128, s42
    v_perm_b32 v158, v140, v136, s42
    v_perm_b32 v159, v148, v144, s42
    v_perm_b32 v160, v125, v121, s41
    v_perm_b32 v161, v133, v129, s41
    v_perm_b32 v162, v141, v137, s41
    v_perm_b32 v163, v149, v145, s41
    v_perm_b32 v164, v125, v121, s42
    v_perm_b32 v165, v133, v129, s42
    v_perm_b32 v166, v141, v137, s42
    v_perm_b32 v167, v149, v145, s42
    v_perm_b32 v168, v126, v122, s41
    v_perm_b32 v169, v134, v130, s41
    v_perm_b32 v170, v142, v138, s41
    v_perm_b32 v171, v150, v146, s41
    v_perm_b32 v172, v126, v122, s42
    v_perm_b32 v173, v134, v130, s42
    v_perm_b32 v174, v142, v138, s42
    v_perm_b32 v175, v150, v146, s42
    v_perm_b32 v176, v127, v123, s41
    v_perm_b32 v177, v135, v131, s41
    v_perm_b32 v178, v143, v139, s41
    v_perm_b32 v179, v151, v147, s41
    v_perm_b32 v180, v127, v123, s42
    v_perm_b32 v181, v135, v131, s42
    v_perm_b32 v182, v143, v139, s42
    v_perm_b32 v183, v151, v147, s42
    v_mfma_f32_16x16x32_bf16 v[184:187], v[60:63], v[152:155], 0
    v_mfma_f32_16x16x32_bf16 v[188:191], v[60:63], v[156:159], 0
    v_mfma_f32_16x16x32_bf16 v[192:195], v[60:63], v[160:163], 0
    v_mfma_f32_16x16x32_bf16 v[196:199], v[60:63], v[164:167], 0
    v_mfma_f32_16x16x32_bf16 v[200:203], v[60:63], v[168:171], 0
    v_mfma_f32_16x16x32_bf16 v[204:207], v[60:63], v[172:175], 0
    v_mfma_f32_16x16x32_bf16 v[208:211], v[60:63], v[176:179], 0
    v_mfma_f32_16x16x32_bf16 v[212:215], v[60:63], v[180:183], 0
    v_and_b32 v10, 15, v2
    v_lshlrev_b32 v10, 4, v10
    v_lshrrev_b32 v11, 5, v2
    v_lshl_add_u32 v10, v11, 8, v10
    v_and_b32 v11, 1, v5
    v_lshl_add_u32 v10, v11, 13, v10
    s_lshl_b32 s41, s3, 9
    s_add_u32 s41, s41, 131072
    v_add_u32 v10, s41, v10
    v_cvt_pk_bf16_f32 v152, v184, v188
    v_cvt_pk_bf16_f32 v153, v192, v196
    v_cvt_pk_bf16_f32 v154, v200, v204
    v_cvt_pk_bf16_f32 v155, v208, v212
    v_cvt_pk_bf16_f32 v156, v185, v189
    v_cvt_pk_bf16_f32 v157, v193, v197
    v_cvt_pk_bf16_f32 v158, v201, v205
    v_cvt_pk_bf16_f32 v159, v209, v213
    v_cvt_pk_bf16_f32 v160, v186, v190
    v_cvt_pk_bf16_f32 v161, v194, v198
    v_cvt_pk_bf16_f32 v162, v202, v206
    v_cvt_pk_bf16_f32 v163, v210, v214
    v_cvt_pk_bf16_f32 v164, v187, v191
    v_cvt_pk_bf16_f32 v165, v195, v199
    v_cvt_pk_bf16_f32 v166, v203, v207
    v_cvt_pk_bf16_f32 v167, v211, v215
    ds_write_b128 v10, v[152:155] offset:0
    ds_write_b128 v10, v[156:159] offset:2048
    ds_write_b128 v10, v[160:163] offset:4096
    ds_write_b128 v10, v[164:167] offset:6144
    v_mov_b32 v216, 162820
    v_mov_b32 v217, 1
    ds_add_u32 v216, v217
    v_mov_b32 v216, 162820
L_lw_37:
    ds_read_b32 v217, v216
    s_waitcnt lgkmcnt(0)
    v_readfirstlane_b32 s40, v217
    s_nop 0
    s_cmp_ge_u32 s40, 256
    s_cbranch_scc0 L_lw_37
L_row:
    ds_read_b64_tr_b16 v[120:121], v224 offset:0
    ds_read_b64_tr_b16 v[122:123], v224 offset:512
    ds_read_b64_tr_b16 v[124:125], v224 offset:1024
    ds_read_b64_tr_b16 v[126:127], v224 offset:1536
    ds_read_b64_tr_b16 v[128:129], v224 offset:2048
    ds_read_b64_tr_b16 v[130:131], v224 offset:2560
    ds_read_b64_tr_b16 v[132:133], v224 offset:3072
    ds_read_b64_tr_b16 v[134:135], v224 offset:3584
    s_waitcnt lgkmcnt(0)
    s_cmp_eq_u32 s51, 0
    s_cbranch_scc1 L_cplx_38
    v_mov_b32 v128, 0
    v_mov_b32 v129, 0
    v_mov_b32 v130, 0
    v_mov_b32 v131, 0
    v_mov_b32 v132, 0
    v_mov_b32 v133, 0
    v_mov_b32 v134, 0
    v_mov_b32 v135, 0
    s_nop 1
L_cplx_38:
    v_mfma_f32_32x32x16_bf16 v[136:151], v[120:123], v[64:67], 0
    v_mfma_f32_32x32x16_bf16 v[152:167], v[128:131], v[64:67], 0
    v_mfma_f32_32x32x16_bf16 v[136:151], v[124:127], v[68:71], v[136:151]
    v_mfma_f32_32x32x16_bf16 v[152:167], v[132:135], v[68:71], v[152:167]
    v_mfma_f32_32x32x16_bf16 v[136:151], v[128:131], v[72:75], v[136:151]
    v_mfma_f32_32x32x16_bf16 v[152:167], v[120:123], v[80:83], v[152:167]
    v_mfma_f32_32x32x16_bf16 v[136:151], v[132:135], v[76:79], v[136:151]
    v_mfma_f32_32x32x16_bf16 v[152:167], v[124:127], v[84:87], v[152:167]
    s_nop 10
    v_mul_f32 v184, v136, v88
    v_mul_f32 v200, v152, v88
    v_fmac_f32 v184, v152, v104
    v_fma_f32 v200, -v136, v104, v200
    v_mul_f32 v185, v137, v89
    v_mul_f32 v201, v153, v89
    v_fmac_f32 v185, v153, v105
    v_fma_f32 v201, -v137, v105, v201
    v_mul_f32 v186, v138, v90
    v_mul_f32 v202, v154, v90
    v_fmac_f32 v186, v154, v106
    v_fma_f32 v202, -v138, v106, v202
    v_mul_f32 v187, v139, v91
    v_mul_f32 v203, v155, v91
    v_fmac_f32 v187, v155, v107
    v_fma_f32 v203, -v139, v107, v203
    v_mul_f32 v188, v140, v92
    v_mul_f32 v204, v156, v92
    v_fmac_f32 v188, v156, v108
    v_fma_f32 v204, -v140, v108, v204
    v_mul_f32 v189, v141, v93
    v_mul_f32 v205, v157, v93
    v_fmac_f32 v189, v157, v109
    v_fma_f32 v205, -v141, v109, v205
    v_mul_f32 v190, v142, v94
    v_mul_f32 v206, v158, v94
    v_fmac_f32 v190, v158, v110
    v_fma_f32 v206, -v142, v110, v206
    v_mul_f32 v191, v143, v95
    v_mul_f32 v207, v159, v95
    v_fmac_f32 v191, v159, v111
    v_fma_f32 v207, -v143, v111, v207
    v_mul_f32 v192, v144, v96
    v_mul_f32 v208, v160, v96
    v_fmac_f32 v192, v160, v112
    v_fma_f32 v208, -v144, v112, v208
    v_mul_f32 v193, v145, v97
    v_mul_f32 v209, v161, v97
    v_fmac_f32 v193, v161, v113
    v_fma_f32 v209, -v145, v113, v209
    v_mul_f32 v194, v146, v98
    v_mul_f32 v210, v162, v98
    v_fmac_f32 v194, v162, v114
    v_fma_f32 v210, -v146, v114, v210
    v_mul_f32 v195, v147, v99
    v_mul_f32 v211, v163, v99
    v_fmac_f32 v195, v163, v115
    v_fma_f32 v211, -v147, v115, v211
    v_mul_f32 v196, v148, v100
    v_mul_f32 v212, v164, v100
    v_fmac_f32 v196, v164, v116
    v_fma_f32 v212, -v148, v116, v212
    v_mul_f32 v197, v149, v101
    v_mul_f32 v213, v165, v101
    v_fmac_f32 v197, v165, v117
    v_fma_f32 v213, -v149, v117, v213
    v_mul_f32 v198, v150, v102
    v_mul_f32 v214, v166, v102
    v_fmac_f32 v198, v166, v118
    v_fma_f32 v214, -v150, v118, v214
    v_mul_f32 v199, v151, v103
    v_mul_f32 v215, v167, v103
    v_fmac_f32 v199, v167, v119
    v_fma_f32 v215, -v151, v119, v215
    v_cvt_pk_bf16_f32 v168, v184, v185
    v_cvt_pk_bf16_f32 v176, v200, v201
    v_cvt_pk_bf16_f32 v169, v186, v187
    v_cvt_pk_bf16_f32 v177, v202, v203
    v_cvt_pk_bf16_f32 v170, v188, v189
    v_cvt_pk_bf16_f32 v178, v204, v205
    v_cvt_pk_bf16_f32 v171, v190, v191
    v_cvt_pk_bf16_f32 v179, v206, v207
    v_cvt_pk_bf16_f32 v172, v192, v193
    v_cvt_pk_bf16_f32 v180, v208, v209
    v_cvt_pk_bf16_f32 v173, v194, v195
    v_cvt_pk_bf16_f32 v181, v210, v211
    v_cvt_pk_bf16_f32 v174, v196, v197
    v_cvt_pk_bf16_f32 v182, v212, v213
    v_cvt_pk_bf16_f32 v175, v198, v199
    v_cvt_pk_bf16_f32 v183, v214, v215
    v_mfma_f32_32x32x16_bf16 v[136:151], v[168:171], v[64:67], 0
    v_mfma_f32_32x32x16_bf16 v[136:151], v[172:175], v[68:71], v[136:151]
    v_mfma_f32_32x32x16_bf16 v[136:151], v[176:179], v[72:75], v[136:151]
    v_mfma_f32_32x32x16_bf16 v[136:151], v[180:183], v[76:79], v[136:151]
    s_lshl_b32 s41, s50, 12
    s_sub_u32 s42, 2048, s50
    s_lshl_b32 s42, s42, 12
    s_nop 8
    ds_bpermute_b32 v152, v227, v136
    v_cvt_pk_bf16_f32 v184, v136, v137
    v_cvt_pk_bf16_f32 v185, v138, v139
    v_cvt_pk_bf16_f32 v186, v140, v141
    v_cvt_pk_bf16_f32 v187, v142, v143
    v_cvt_pk_bf16_f32 v188, v144, v145
    v_cvt_pk_bf16_f32 v189, v146, v147
    v_cvt_pk_bf16_f32 v190, v148, v149
    v_cvt_pk_bf16_f32 v191, v150, v151
    v_mov_b32 v216, 162860
L_lw_39:
    ds_read_b32 v217, v216
    s_waitcnt lgkmcnt(0)
    v_readfirstlane_b32 s40, v217
    s_nop 0
    s_cmp_ge_u32 s40, 256
    s_sleep 4
    s_cbranch_scc0 L_lw_39
    s_mov_b32 s56, 0xaaaaaaaa
    s_mov_b32 s57, 0xaaaaaaaa
    v_cndmask_b32 v120, v188, v184, s[56:57]
    v_cndmask_b32 v121, v189, v185, s[56:57]
    v_cndmask_b32 v122, v190, v186, s[56:57]
    v_cndmask_b32 v123, v191, v187, s[56:57]
    v_mov_b32_dpp v128, v120 quad_perm:[1,0,3,2] row_mask:0xf bank_mask:0xf
    v_mov_b32_dpp v129, v121 quad_perm:[1,0,3,2] row_mask:0xf bank_mask:0xf
    v_mov_b32_dpp v130, v122 quad_perm:[1,0,3,2] row_mask:0xf bank_mask:0xf
    v_mov_b32_dpp v131, v123 quad_perm:[1,0,3,2] row_mask:0xf bank_mask:0xf
    v_cndmask_b32 v184, v184, v128, s[56:57]
    v_cndmask_b32 v188, v128, v188, s[56:57]
    v_cndmask_b32 v185, v185, v129, s[56:57]
    v_cndmask_b32 v189, v129, v189, s[56:57]
    v_cndmask_b32 v186, v186, v130, s[56:57]
    v_cndmask_b32 v190, v130, v190, s[56:57]
    v_cndmask_b32 v187, v187, v131, s[56:57]
    v_cndmask_b32 v191, v131, v191, s[56:57]
    buffer_store_dwordx4 v[184:187], v225, s[32:35], s41 offen sc1 nt
    buffer_store_dwordx4 v[188:191], v229, s[32:35], s41 offen sc1 nt
    s_waitcnt lgkmcnt(0)
    s_cmp_lg_u32 s51, 0
    s_cbranch_scc1 L_nomir_40
    v_cvt_pk_bf16_f32 v200, v152, v151
    v_cvt_pk_bf16_f32 v201, v150, v149
    v_cvt_pk_bf16_f32 v202, v148, v147
    v_cvt_pk_bf16_f32 v203, v146, v145
    v_cvt_pk_bf16_f32 v204, v144, v143
    v_cvt_pk_bf16_f32 v205, v142, v141
    v_cvt_pk_bf16_f32 v206, v140, v139
    v_cvt_pk_bf16_f32 v207, v138, v137
    v_cndmask_b32 v120, v204, v200, s[56:57]
    v_cndmask_b32 v121, v205, v201, s[56:57]
    v_cndmask_b32 v122, v206, v202, s[56:57]
    v_cndmask_b32 v123, v207, v203, s[56:57]
    v_mov_b32_dpp v128, v120 quad_perm:[1,0,3,2] row_mask:0xf bank_mask:0xf
    v_mov_b32_dpp v129, v121 quad_perm:[1,0,3,2] row_mask:0xf bank_mask:0xf
    v_mov_b32_dpp v130, v122 quad_perm:[1,0,3,2] row_mask:0xf bank_mask:0xf
    v_mov_b32_dpp v131, v123 quad_perm:[1,0,3,2] row_mask:0xf bank_mask:0xf
    v_cndmask_b32 v200, v200, v128, s[56:57]
    v_cndmask_b32 v204, v128, v204, s[56:57]
    v_cndmask_b32 v201, v201, v129, s[56:57]
    v_cndmask_b32 v205, v129, v205, s[56:57]
    v_cndmask_b32 v202, v202, v130, s[56:57]
    v_cndmask_b32 v206, v130, v206, s[56:57]
    v_cndmask_b32 v203, v203, v131, s[56:57]
    v_cndmask_b32 v207, v131, v207, s[56:57]
    buffer_store_dwordx4 v[200:203], v226, s[32:35], s42 offen sc1 nt
    buffer_store_dwordx4 v[204:207], v230, s[32:35], s42 offen sc1 nt
L_nomir_40:
    s_cmp_lg_u32 s52, 0
    s_cbranch_scc1 L_ldone
    s_cmp_eq_u32 s51, 0
    s_cbranch_scc1 L_ldone
    s_mov_b32 s52, 1
    s_movk_i32 s50, 1024
    v_add_u32 v224, 2048, v224
    s_branch L_row
L_ldone:
    s_endpgm
L_compute:
    v_mov_b32 v210, v2
    v_lshlrev_b32 v211, 4, v2
    s_getpc_b64 s[50:51]
L_pc:
    s_and_b32 s50, s50, 0xffffff00
    s_sub_u32 s50, s50, ((L_pc - concat_heads__sliding_local_dilated__spectral_fnet__prompt_kernel) & 0xffffff00)
    s_subb_u32 s51, s51, 0
    s_lshl_b32 s41, s5, 2
    s_add_u32 s41, s41, s3
    s_lshl_b32 s41, s41, 8
    s_min_u32 s41, s41, ((L_end - concat_heads__sliding_local_dilated__spectral_fnet__prompt_kernel - 256) & 0xffffff00)
    v_and_b32 v3, 1, v2
    v_lshlrev_b32 v3, 7, v3
    v_add_u32 v3, s41, v3
    global_load_dword v226, v3, s[50:51]
    v_and_b32 v44, 15, v2
    v_lshlrev_b32 v44, 2, v44
    v_add_u32 v44, 162816, v44
    v_mov_b32 v45, 0
    ds_write_b32 v44, v45
    s_waitcnt lgkmcnt(0)
    s_and_b32 s41, s4, 2
    s_or_b32 s41, s41, s3
    s_cmp_lg_u32 s41, 0
    s_cbranch_scc1 L_noc3
    s_cmp_ge_u32 s5, 24
    s_cbranch_scc1 L_noc3
    s_and_b32 s41, s4, 1
    s_lshl_b32 s41, s41, 1
    s_lshr_b32 s42, s4, 1
    s_add_u32 s41, s41, s42
    s_and_b32 s41, s41, 3
    s_mul_i32 s41, s41, 768
    s_lshl_b32 s43, s5, 6
    s_add_u32 s41, s41, s43
    v_add_u32 v3, s41, v2
    v_subrev_u32 v4, 3072, v3
    v_min_u32 v3, v3, v4
    v_lshlrev_b32 v3, 11, v3
    s_lshl_b32 s42, s42, 9
    s_add_u32 s42, s42, 384
    buffer_load_dword v227, v3, s[20:23], s42 offen
L_noc3:
    s_cmp_lg_u32 s2, 0
    s_cbranch_scc1 L_nozero
    v_mov_b32 v4, 0
    v_mov_b32 v5, 0
    v_mov_b32 v6, 0
    v_mov_b32 v7, 0
    v_lshlrev_b32 v3, 7, v2
    s_lshl_b32 s41, s3, 13
    s_add_u32 s41, s41, 8388608
    buffer_store_dwordx4 v[4:7], v3, s[36:39], s41 offen sc1
    v_lshrrev_b32 v3, 1, v2
    v_lshlrev_b32 v3, 7, v3
    v_and_b32 v8, 1, v2
    v_lshl_add_u32 v3, v8, 4, v3
    s_mov_b32 s41, 8454144
    buffer_store_dwordx4 v[4:7], v3, s[36:39], s41 offen sc1
    s_nop 1
L_nozero:
    v_and_b32 v3, 4, v2
    v_lshlrev_b32 v3, 2, v3
    v_lshrrev_b32 v4, 1, v2
    v_and_b32 v4, 12, v4
    v_and_b32 v5, 3, v2
    v_or_b32 v3, v3, v4
    v_or_b32 v3, v3, v5
    s_mov_b32 s41, 0x3d000000
    s_cmp_ge_u32 s3, 2
    s_cselect_b32 s41, 0x3a800000, s41
    s_and_b32 s42, s3, 1
    s_cselect_b32 s42, 0xbe800000, 0
    v_cvt_f32_u32 v3, v3
    v_mul_f32 v3, s41, v3
    v_lshrrev_b32 v4, 5, v2
    v_lshlrev_b32 v4, 2, v4
    v_cvt_f32_u32 v4, v4
    v_mov_b32 v5, s42
    v_fma_f32 v4, v3, v4, v5
    v_fmamk_f32 v8, v3, 0x00000000, v4
    v_fmamk_f32 v9, v3, 0x3f800000, v4
    v_fmamk_f32 v10, v3, 0x40000000, v4
    v_fmamk_f32 v11, v3, 0x40400000, v4
    v_fmamk_f32 v12, v3, 0x41000000, v4
    v_fmamk_f32 v13, v3, 0x41100000, v4
    v_fmamk_f32 v14, v3, 0x41200000, v4
    v_fmamk_f32 v15, v3, 0x41300000, v4
    v_fmamk_f32 v16, v3, 0x41800000, v4
    v_fmamk_f32 v17, v3, 0x41880000, v4
    v_fmamk_f32 v18, v3, 0x41900000, v4
    v_fmamk_f32 v19, v3, 0x41980000, v4
    v_fmamk_f32 v20, v3, 0x41c00000, v4
    v_fmamk_f32 v21, v3, 0x41c80000, v4
    v_fmamk_f32 v22, v3, 0x41d00000, v4
    v_fmamk_f32 v23, v3, 0x41d80000, v4
    v_cos_f32 v8, v8
    v_cos_f32 v9, v9
    v_cos_f32 v10, v10
    v_cos_f32 v11, v11
    v_cos_f32 v12, v12
    v_cos_f32 v13, v13
    v_cos_f32 v14, v14
    v_cos_f32 v15, v15
    v_cos_f32 v16, v16
    v_cos_f32 v17, v17
    v_cos_f32 v18, v18
    v_cos_f32 v19, v19
    v_cos_f32 v20, v20
    v_cos_f32 v21, v21
    v_cos_f32 v22, v22
    v_cos_f32 v23, v23
    v_add_u32 v6, 147456, v211
    s_cmp_ge_u32 s3, 2
    s_cbranch_scc1 L_tw
    v_cvt_pk_bf16_f32 v24, v8, v9
    v_cvt_pk_bf16_f32 v25, v10, v11
    v_cvt_pk_bf16_f32 v26, v12, v13
    v_cvt_pk_bf16_f32 v27, v14, v15
    v_cvt_pk_bf16_f32 v28, v16, v17
    v_cvt_pk_bf16_f32 v29, v18, v19
    v_cvt_pk_bf16_f32 v30, v20, v21
    v_cvt_pk_bf16_f32 v31, v22, v23
    s_cmp_eq_u32 s3, 0
    s_cbranch_scc1 L_cc
    v_xor_b32 v32, 0x80008000, v24
    v_xor_b32 v33, 0x80008000, v25
    v_xor_b32 v34, 0x80008000, v26
    v_xor_b32 v35, 0x80008000, v27
    v_xor_b32 v36, 0x80008000, v28
    v_xor_b32 v37, 0x80008000, v29
    v_xor_b32 v38, 0x80008000, v30
    v_xor_b32 v39, 0x80008000, v31
    ds_write_b128 v6, v[24:27] offset:3072
    ds_write_b128 v6, v[28:31] offset:4096
    ds_write_b128 v6, v[32:35] offset:5120
    ds_write_b128 v6, v[36:39] offset:6144
    s_branch L_cdone
L_cc:
    ds_write_b128 v6, v[24:27] offset:1024
    ds_write_b128 v6, v[28:31] offset:2048
    v_bfe_u32 v8, v2, 1, 2
    v_and_b32 v9, 1, v2
    s_and_b32 s41, s5, 1
    s_lshl_b32 s42, s41, 2
    v_add_u32 v10, s42, v8
    v_cvt_f32_u32 v10, v10
    v_mul_f32 v10, 0x3e000000, v10
    v_cvt_f32_u32 v11, v9
    v_mul_f32 v11, 0x3e800000, v11
    v_add_f32 v12, 0xbe800000, v11
    v_lshrrev_b32 v13, 5, v2
    v_bfe_u32 v14, v2, 3, 1
    v_cmp_eq_u32 vcc, v13, v14
    s_nop 1
    v_cndmask_b32 v13, 0, 1.0, vcc
    v_mov_b32 v14, v13
    s_lshl_b32 s42, s4, 4
    s_add_u32 s42, s42, s9
    s_cmp_lg_u32 s42, 0
    s_cbranch_scc1 L_hgen
    s_cmp_eq_u32 s41, 0
    s_cbranch_scc0 L_h1
    v_mov_b32 v14, 0
    v_and_b32 v15, 7, v2
    v_cmp_eq_u32 vcc, 1, v15
    s_nop 1
    v_cndmask_b32 v10, v10, 0.5, vcc
    v_cndmask_b32 v11, v11, 0, vcc
    s_branch L_hgen
L_h1:
    v_mov_b32 v13, 0
    v_mov_b32 v12, v11
    v_lshl_add_u32 v15, v8, 1, 1
    v_cvt_f32_u32 v10, v15
    v_mul_f32 v10, 0x3d800000, v10
L_hgen:
    v_bfe_u32 v15, v2, 4, 1
    v_lshlrev_b32 v15, 2, v15
    v_cvt_f32_u32 v15, v15
    v_fmac_f32 v11, v10, v15
    v_fmac_f32 v12, v10, v15
    v_cos_f32 v16, v11
    v_cos_f32 v17, v12
    v_add_f32 v11, v11, v10
    v_add_f32 v12, v12, v10
    v_mul_f32 v16, v16, v13
    v_mul_f32 v17, v17, v14
    v_cvt_pk_bf16_f32 v40, v16, v17
    v_cos_f32 v16, v11
    v_cos_f32 v17, v12
    v_add_f32 v11, v11, v10
    v_add_f32 v12, v12, v10
    v_mul_f32 v16, v16, v13
    v_mul_f32 v17, v17, v14
    v_cvt_pk_bf16_f32 v41, v16, v17
    v_cos_f32 v16, v11
    v_cos_f32 v17, v12
    v_add_f32 v11, v11, v10
    v_add_f32 v12, v12, v10
    v_mul_f32 v16, v16, v13
    v_mul_f32 v17, v17, v14
    v_cvt_pk_bf16_f32 v42, v16, v17
    v_cos_f32 v16, v11
    v_cos_f32 v17, v12
    v_add_f32 v11, v11, v10
    v_add_f32 v12, v12, v10
    v_mul_f32 v16, v16, v13
    v_mul_f32 v17, v17, v14
    v_cvt_pk_bf16_f32 v43, v16, v17
    ds_write_b128 v6, v[40:43]
    s_branch L_cdone
L_tw:
    s_sub_u32 s41, s3, 2
    s_lshl_b32 s41, s41, 12
    v_add_u32 v6, s41, v6
    ds_write_b128 v6, v[8:11] offset:7168
    ds_write_b128 v6, v[12:15] offset:8192
    ds_write_b128 v6, v[16:19] offset:9216
    ds_write_b128 v6, v[20:23] offset:10240
L_cdone:
    v_and_b32 v214, 15, v210
    v_lshrrev_b32 v215, 4, v210
    v_lshrrev_b32 v216, 1, v214
    v_xor_b32 v216, v216, v215
    v_lshlrev_b32 v216, 4, v216
    v_lshl_add_u32 v216, v214, 7, v216
    v_xor_b32 v217, 64, v216
    s_lshr_b32 s41, s3, 1
    s_lshl_b32 s41, s41, 13
    s_add_u32 s41, s41, 2048
    v_add_u32 v198, 0, v216
    v_add_u32 v192, s41, v198
    v_add_u32 v199, 0, v217
    v_add_u32 v193, s41, v199
    v_add_u32 v200, 43008, v216
    v_add_u32 v194, s41, v200
    v_add_u32 v201, 43008, v217
    v_add_u32 v195, s41, v201
    v_add_u32 v202, 86016, v216
    v_add_u32 v196, s41, v202
    v_add_u32 v203, 86016, v217
    v_add_u32 v197, s41, v203
    v_lshrrev_b32 v218, 2, v214
    v_and_b32 v219, 3, v214
    v_lshl_add_u32 v220, v215, 3, v218
    v_lshlrev_b32 v220, 7, v220
    v_lshrrev_b32 v221, 1, v218
    v_and_b32 v222, 1, v215
    v_lshl_add_u32 v221, v222, 1, v221
    v_lshlrev_b32 v221, 1, v221
    s_and_b32 s41, s3, 1
    s_lshl_b32 s41, s41, 2
    v_lshrrev_b32 v222, 1, v219
    v_add_u32 v223, s41, v222
    v_xor_b32 v223, v223, v221
    v_lshl_add_u32 v220, v223, 4, v220
    v_and_b32 v219, 1, v219
    v_lshl_add_u32 v220, v219, 3, v220
    v_xor_b32 v223, 32, v220
    v_add_u32 v204, 18432, v220
    v_add_u32 v205, 18432, v223
    v_add_u32 v206, 61440, v220
    v_add_u32 v207, 61440, v223
    v_add_u32 v208, 104448, v220
    v_add_u32 v209, 104448, v223
    v_lshl_add_u32 v220, v215, 2, v218
    v_lshlrev_b32 v220, 7, v220
    v_lshl_add_u32 v220, v219, 3, v220
    v_xor_b32 v222, v222, v221
    v_lshl_add_u32 v244, v222, 4, v220
    v_xor_b32 v245, 32, v244
    v_xor_b32 v246, 64, v244
    v_xor_b32 v247, 96, v244
    s_mov_b32 s56, 0xaaaaaaaa
    s_mov_b32 s57, 0xaaaaaaaa
    v_mov_b32 v218, 0xce6e6b28
    v_lshlrev_b32 v216, 2, v215
    v_sub_u32 v216, v214, v216
    v_add_u32 v217, 16, v216
    v_and_b32 v217, 0xfffffff1, v217
    v_cmp_eq_u32 vcc, 0, v217
    s_nop 1
    v_cndmask_b32 v228, v218, 0, vcc
    v_add_u32 v217, 15, v216
    v_and_b32 v217, 0xfffffff1, v217
    v_cmp_eq_u32 vcc, 0, v217
    s_nop 1
    v_cndmask_b32 v229, v218, 0, vcc
    v_add_u32 v217, 14, v216
    v_and_b32 v217, 0xfffffff1, v217
    v_cmp_eq_u32 vcc, 0, v217
    s_nop 1
    v_cndmask_b32 v230, v218, 0, vcc
    v_add_u32 v217, 13, v216
    v_and_b32 v217, 0xfffffff1, v217
    v_cmp_eq_u32 vcc, 0, v217
    s_nop 1
    v_cndmask_b32 v231, v218, 0, vcc
    v_add_u32 v217, 0, v216
    v_and_b32 v217, 0xfffffff1, v217
    v_cmp_eq_u32 vcc, 0, v217
    s_nop 1
    v_cndmask_b32 v232, v218, 0, vcc
    v_add_u32 v217, -1, v216
    v_and_b32 v217, 0xfffffff1, v217
    v_cmp_eq_u32 vcc, 0, v217
    s_nop 1
    v_cndmask_b32 v233, v218, 0, vcc
    v_add_u32 v217, -2, v216
    v_and_b32 v217, 0xfffffff1, v217
    v_cmp_eq_u32 vcc, 0, v217
    s_nop 1
    v_cndmask_b32 v234, v218, 0, vcc
    v_add_u32 v217, -3, v216
    v_and_b32 v217, 0xfffffff1, v217
    v_cmp_eq_u32 vcc, 0, v217
    s_nop 1
    v_cndmask_b32 v235, v218, 0, vcc
    s_lshr_b32 s41, s3, 1
    s_or_b32 s41, s41, s6
    s_cmp_eq_u32 s41, 0
    s_cselect_b64 vcc, -1, 0
    v_cndmask_b32 v236, v228, v218, vcc
    v_cndmask_b32 v237, v229, v218, vcc
    v_cndmask_b32 v238, v230, v218, vcc
    v_cndmask_b32 v239, v231, v218, vcc
    v_mov_b32 v216, 0x0c0c0100
    v_mov_b32 v217, 0x01000c0c
    v_cndmask_b32 v212, v216, v217, s[56:57]
    v_mov_b32 v216, 0x0c0c0302
    v_mov_b32 v217, 0x03020c0c
    v_cndmask_b32 v213, v216, v217, s[56:57]
    s_waitcnt lgkmcnt(0)
    v_mov_b32 v0, 0
    v_mov_b32 v1, 0
    v_mov_b32 v2, 0
    v_mov_b32 v3, 0
    v_mov_b32 v4, 0
    v_mov_b32 v5, 0
    v_mov_b32 v6, 0
    v_mov_b32 v7, 0
    v_mov_b32 v8, 0
    v_mov_b32 v9, 0
    v_mov_b32 v10, 0
    v_mov_b32 v11, 0
    v_mov_b32 v12, 0
    v_mov_b32 v13, 0
    v_mov_b32 v14, 0
    v_mov_b32 v15, 0
    v_mov_b32 v16, 0
    v_mov_b32 v17, 0
    v_mov_b32 v18, 0
    v_mov_b32 v19, 0
    v_mov_b32 v20, 0
    v_mov_b32 v21, 0
    v_mov_b32 v22, 0
    v_mov_b32 v23, 0
    v_mov_b32 v24, 0
    v_mov_b32 v25, 0
    v_mov_b32 v26, 0
    v_mov_b32 v27, 0
    v_mov_b32 v28, 0
    v_mov_b32 v29, 0
    v_mov_b32 v30, 0
    v_mov_b32 v31, 0
    v_mov_b32 v32, 0
    v_mov_b32 v33, 0
    v_mov_b32 v34, 0
    v_mov_b32 v35, 0
    v_mov_b32 v36, 0
    v_mov_b32 v37, 0
    v_mov_b32 v38, 0
    v_mov_b32 v39, 0
    v_mov_b32 v40, 0
    v_mov_b32 v41, 0
    v_mov_b32 v42, 0
    v_mov_b32 v43, 0
    v_mov_b32 v44, 0
    v_mov_b32 v45, 0
    v_mov_b32 v46, 0
    v_mov_b32 v47, 0
    v_mov_b32 v48, 0
    v_mov_b32 v49, 0
    v_mov_b32 v50, 0
    v_mov_b32 v51, 0
    v_mov_b32 v52, 0
    v_mov_b32 v53, 0
    v_mov_b32 v54, 0
    v_mov_b32 v55, 0
    v_mov_b32 v56, 0
    v_mov_b32 v57, 0
    v_mov_b32 v58, 0
    v_mov_b32 v59, 0
    v_mov_b32 v60, 0
    v_mov_b32 v61, 0
    v_mov_b32 v62, 0
    v_mov_b32 v63, 0
    v_mov_b32 v64, 0
    v_mov_b32 v65, 0
    v_mov_b32 v66, 0
    v_mov_b32 v67, 0
    v_mov_b32 v68, 0
    v_mov_b32 v69, 0
    v_mov_b32 v70, 0
    v_mov_b32 v71, 0
    v_mov_b32 v72, 0
    v_mov_b32 v73, 0
    v_mov_b32 v74, 0
    v_mov_b32 v75, 0
    v_mov_b32 v76, 0
    v_mov_b32 v77, 0
    v_mov_b32 v78, 0
    v_mov_b32 v79, 0
    v_mov_b32 v80, 0
    v_mov_b32 v81, 0
    v_mov_b32 v82, 0
    v_mov_b32 v83, 0
    v_mov_b32 v84, 0
    v_mov_b32 v85, 0
    v_mov_b32 v86, 0
    v_mov_b32 v87, 0
    v_mov_b32 v88, 0
    v_mov_b32 v89, 0
    v_mov_b32 v90, 0
    v_mov_b32 v91, 0
    v_mov_b32 v92, 0
    v_mov_b32 v93, 0
    v_mov_b32 v94, 0
    v_mov_b32 v95, 0
    v_mov_b32 v96, 0
    v_mov_b32 v97, 0
    v_mov_b32 v98, 0
    v_mov_b32 v99, 0
    v_mov_b32 v100, 0
    v_mov_b32 v101, 0
    v_mov_b32 v102, 0
    v_mov_b32 v103, 0
    s_cmp_lg_u32 s2, 0
    s_cbranch_scc1 L_nogo
    v_mov_b32 v224, 1
    v_mov_b32 v225, 0
    s_lshl_b32 s41, s3, 2
    s_waitcnt vmcnt(0)
    s_mov_b64 exec, 1
    buffer_store_dword v224, v225, s[12:15], s41 offen sc1
    s_mov_b64 exec, -1
L_nogo:
    v_mov_b32 v224, 1
    v_mov_b32 v225, 162816
    s_waitcnt lgkmcnt(0)
    s_and_b32 s41, s3, 1
    s_lshl_b32 s41, s41, 3
    s_add_u32 s41, s41, 162832
    v_mov_b32 v223, s41
    s_and_b32 s41, s3, 1
    s_lshl_b32 s41, s41, 12
    s_add_u32 s41, s41, 147456
    v_add_u32 v214, s41, v211
    v_lshlrev_b32 v215, 3, v210
    v_add_u32 v215, s41, v215
    s_cmp_ge_u32 s3, 2
    s_cbranch_scc1 L_c1
    s_barrier
    ds_read_b128 v[104:107], v192 offset:0
    ds_read_b64_tr_b16 v[124:125], v204 offset:0
    ds_read_b64_tr_b16 v[126:127], v204 offset:512
    ds_read_b64_tr_b16 v[128:129], v205 offset:0
    ds_read_b64_tr_b16 v[130:131], v205 offset:512
    ds_read_b128 v[108:111], v192 offset:2048
    ds_read_b64_tr_b16 v[132:133], v204 offset:8192
    ds_read_b64_tr_b16 v[134:135], v204 offset:8704
    ds_read_b64_tr_b16 v[136:137], v205 offset:8192
    ds_read_b64_tr_b16 v[138:139], v205 offset:8704
    ds_read_b128 v[112:115], v192 offset:4096
    ds_read_b64_tr_b16 v[140:141], v204 offset:16384
    ds_read_b64_tr_b16 v[142:143], v204 offset:16896
    ds_read_b64_tr_b16 v[144:145], v205 offset:16384
    ds_read_b64_tr_b16 v[146:147], v205 offset:16896
    ds_read_b128 v[116:119], v192 offset:6144
    ds_read_b128 v[120:123], v198
    s_mov_b32 s40, 5
L_cl0:
    s_waitcnt lgkmcnt(0)
    v_mfma_f32_16x16x32_bf16 v[96:99], v[132:135], v[120:123], v[96:99]
    ds_read_b128 v[148:151], v193 offset:0
    v_mfma_f32_16x16x32_bf16 v[100:103], v[136:139], v[120:123], v[100:103]
    ds_read_b64_tr_b16 v[168:169], v204 offset:4096
    v_mfma_f32_16x16x32_bf16 v[92:95], v[116:119], v[144:147], v[92:95]
    ds_read_b64_tr_b16 v[170:171], v204 offset:4608
    v_mfma_f32_16x16x32_bf16 v[88:91], v[116:119], v[140:143], v[88:91]
    ds_read_b64_tr_b16 v[172:173], v205 offset:4096
    v_mfma_f32_16x16x32_bf16 v[84:87], v[136:139], v[116:119], v[84:87]
    ds_read_b64_tr_b16 v[174:175], v205 offset:4608
    v_mfma_f32_16x16x32_bf16 v[80:83], v[132:135], v[116:119], v[80:83]
    ds_read_b128 v[152:155], v193 offset:2048
    v_mfma_f32_16x16x32_bf16 v[76:79], v[128:131], v[116:119], v[76:79]
    ds_read_b64_tr_b16 v[176:177], v204 offset:12288
    v_mfma_f32_16x16x32_bf16 v[72:75], v[124:127], v[116:119], v[72:75]
    ds_read_b64_tr_b16 v[178:179], v204 offset:12800
    v_mfma_f32_16x16x32_bf16 v[48:51], v[124:127], v[112:115], v[48:51]
    ds_read_b64_tr_b16 v[180:181], v205 offset:12288
    v_mfma_f32_16x16x32_bf16 v[52:55], v[128:131], v[112:115], v[52:55]
    ds_read_b64_tr_b16 v[182:183], v205 offset:12800
    v_mfma_f32_16x16x32_bf16 v[56:59], v[132:135], v[112:115], v[56:59]
    ds_read_b128 v[156:159], v193 offset:4096
    v_mfma_f32_16x16x32_bf16 v[60:63], v[136:139], v[112:115], v[60:63]
    ds_read_b64_tr_b16 v[184:185], v204 offset:20480
    v_mfma_f32_16x16x32_bf16 v[64:67], v[112:115], v[140:143], v[64:67]
    ds_read_b64_tr_b16 v[186:187], v204 offset:20992
    v_mfma_f32_16x16x32_bf16 v[68:71], v[112:115], v[144:147], v[68:71]
    ds_read_b64_tr_b16 v[188:189], v205 offset:20480
    v_mfma_f32_16x16x32_bf16 v[44:47], v[108:111], v[144:147], v[44:47]
    ds_read_b64_tr_b16 v[190:191], v205 offset:20992
    v_mfma_f32_16x16x32_bf16 v[40:43], v[108:111], v[140:143], v[40:43]
    ds_read_b128 v[160:163], v193 offset:6144
    v_mfma_f32_16x16x32_bf16 v[36:39], v[136:139], v[108:111], v[36:39]
    ds_read_b128 v[164:167], v199
    v_mfma_f32_16x16x32_bf16 v[32:35], v[132:135], v[108:111], v[32:35]
    v_mfma_f32_16x16x32_bf16 v[28:31], v[128:131], v[108:111], v[28:31]
    v_mfma_f32_16x16x32_bf16 v[24:27], v[124:127], v[108:111], v[24:27]
    v_mfma_f32_16x16x32_bf16 v[0:3], v[124:127], v[104:107], v[0:3]
    v_mfma_f32_16x16x32_bf16 v[4:7], v[128:131], v[104:107], v[4:7]
    v_mfma_f32_16x16x32_bf16 v[8:11], v[132:135], v[104:107], v[8:11]
    v_mfma_f32_16x16x32_bf16 v[12:15], v[136:139], v[104:107], v[12:15]
    v_mfma_f32_16x16x32_bf16 v[16:19], v[104:107], v[140:143], v[16:19]
    v_mfma_f32_16x16x32_bf16 v[20:23], v[104:107], v[144:147], v[20:23]
    s_waitcnt lgkmcnt(0)
    v_mfma_f32_16x16x32_bf16 v[96:99], v[176:179], v[164:167], v[96:99]
    v_mfma_f32_16x16x32_bf16 v[100:103], v[180:183], v[164:167], v[100:103]
    s_barrier
    ds_read_b128 v[104:107], v194 offset:0
    v_mfma_f32_16x16x32_bf16 v[92:95], v[160:163], v[188:191], v[92:95]
    ds_read_b64_tr_b16 v[124:125], v206 offset:0
    v_mfma_f32_16x16x32_bf16 v[88:91], v[160:163], v[184:187], v[88:91]
    ds_read_b64_tr_b16 v[126:127], v206 offset:512
    v_mfma_f32_16x16x32_bf16 v[84:87], v[180:183], v[160:163], v[84:87]
    ds_read_b64_tr_b16 v[128:129], v207 offset:0
    v_mfma_f32_16x16x32_bf16 v[80:83], v[176:179], v[160:163], v[80:83]
    ds_read_b64_tr_b16 v[130:131], v207 offset:512
    v_mfma_f32_16x16x32_bf16 v[76:79], v[172:175], v[160:163], v[76:79]
    ds_read_b128 v[108:111], v194 offset:2048
    v_mfma_f32_16x16x32_bf16 v[72:75], v[168:171], v[160:163], v[72:75]
    ds_read_b64_tr_b16 v[132:133], v206 offset:8192
    v_mfma_f32_16x16x32_bf16 v[48:51], v[168:171], v[156:159], v[48:51]
    ds_read_b64_tr_b16 v[134:135], v206 offset:8704
    v_mfma_f32_16x16x32_bf16 v[52:55], v[172:175], v[156:159], v[52:55]
    ds_read_b64_tr_b16 v[136:137], v207 offset:8192
    v_mfma_f32_16x16x32_bf16 v[56:59], v[176:179], v[156:159], v[56:59]
    ds_read_b64_tr_b16 v[138:139], v207 offset:8704
    v_mfma_f32_16x16x32_bf16 v[60:63], v[180:183], v[156:159], v[60:63]
    ds_read_b128 v[112:115], v194 offset:4096
    v_mfma_f32_16x16x32_bf16 v[64:67], v[156:159], v[184:187], v[64:67]
    ds_read_b64_tr_b16 v[140:141], v206 offset:16384
    v_mfma_f32_16x16x32_bf16 v[68:71], v[156:159], v[188:191], v[68:71]
    ds_read_b64_tr_b16 v[142:143], v206 offset:16896
    v_mfma_f32_16x16x32_bf16 v[44:47], v[152:155], v[188:191], v[44:47]
    ds_read_b64_tr_b16 v[144:145], v207 offset:16384
    v_mfma_f32_16x16x32_bf16 v[40:43], v[152:155], v[184:187], v[40:43]
    ds_read_b64_tr_b16 v[146:147], v207 offset:16896
    v_mfma_f32_16x16x32_bf16 v[36:39], v[180:183], v[152:155], v[36:39]
    ds_read_b128 v[116:119], v194 offset:6144
    v_mfma_f32_16x16x32_bf16 v[32:35], v[176:179], v[152:155], v[32:35]
    ds_read_b128 v[120:123], v200
    v_mfma_f32_16x16x32_bf16 v[28:31], v[172:175], v[152:155], v[28:31]
    v_mfma_f32_16x16x32_bf16 v[24:27], v[168:171], v[152:155], v[24:27]
    v_mfma_f32_16x16x32_bf16 v[0:3], v[168:171], v[148:151], v[0:3]
    v_mfma_f32_16x16x32_bf16 v[4:7], v[172:175], v[148:151], v[4:7]
    v_mfma_f32_16x16x32_bf16 v[8:11], v[176:179], v[148:151], v[8:11]
    v_mfma_f32_16x16x32_bf16 v[12:15], v[180:183], v[148:151], v[12:15]
    v_mfma_f32_16x16x32_bf16 v[16:19], v[148:151], v[184:187], v[16:19]
    v_mfma_f32_16x16x32_bf16 v[20:23], v[148:151], v[188:191], v[20:23]
    s_waitcnt lgkmcnt(0)
    v_mfma_f32_16x16x32_bf16 v[96:99], v[132:135], v[120:123], v[96:99]
    ds_read_b128 v[148:151], v195 offset:0
    v_mfma_f32_16x16x32_bf16 v[100:103], v[136:139], v[120:123], v[100:103]
    ds_read_b64_tr_b16 v[168:169], v206 offset:4096
    v_mfma_f32_16x16x32_bf16 v[92:95], v[116:119], v[144:147], v[92:95]
    ds_read_b64_tr_b16 v[170:171], v206 offset:4608
    v_mfma_f32_16x16x32_bf16 v[88:91], v[116:119], v[140:143], v[88:91]
    ds_read_b64_tr_b16 v[172:173], v207 offset:4096
    v_mfma_f32_16x16x32_bf16 v[84:87], v[136:139], v[116:119], v[84:87]
    ds_read_b64_tr_b16 v[174:175], v207 offset:4608
    v_mfma_f32_16x16x32_bf16 v[80:83], v[132:135], v[116:119], v[80:83]
    ds_read_b128 v[152:155], v195 offset:2048
    v_mfma_f32_16x16x32_bf16 v[76:79], v[128:131], v[116:119], v[76:79]
    ds_read_b64_tr_b16 v[176:177], v206 offset:12288
    v_mfma_f32_16x16x32_bf16 v[72:75], v[124:127], v[116:119], v[72:75]
    ds_read_b64_tr_b16 v[178:179], v206 offset:12800
    v_mfma_f32_16x16x32_bf16 v[48:51], v[124:127], v[112:115], v[48:51]
    ds_read_b64_tr_b16 v[180:181], v207 offset:12288
    v_mfma_f32_16x16x32_bf16 v[52:55], v[128:131], v[112:115], v[52:55]
    ds_read_b64_tr_b16 v[182:183], v207 offset:12800
    v_mfma_f32_16x16x32_bf16 v[56:59], v[132:135], v[112:115], v[56:59]
    ds_read_b128 v[156:159], v195 offset:4096
    v_mfma_f32_16x16x32_bf16 v[60:63], v[136:139], v[112:115], v[60:63]
    ds_read_b64_tr_b16 v[184:185], v206 offset:20480
    v_mfma_f32_16x16x32_bf16 v[64:67], v[112:115], v[140:143], v[64:67]
    ds_read_b64_tr_b16 v[186:187], v206 offset:20992
    v_mfma_f32_16x16x32_bf16 v[68:71], v[112:115], v[144:147], v[68:71]
    ds_read_b64_tr_b16 v[188:189], v207 offset:20480
    v_mfma_f32_16x16x32_bf16 v[44:47], v[108:111], v[144:147], v[44:47]
    ds_read_b64_tr_b16 v[190:191], v207 offset:20992
    v_mfma_f32_16x16x32_bf16 v[40:43], v[108:111], v[140:143], v[40:43]
    ds_read_b128 v[160:163], v195 offset:6144
    v_mfma_f32_16x16x32_bf16 v[36:39], v[136:139], v[108:111], v[36:39]
    ds_read_b128 v[164:167], v201
    v_mfma_f32_16x16x32_bf16 v[32:35], v[132:135], v[108:111], v[32:35]
    v_mfma_f32_16x16x32_bf16 v[28:31], v[128:131], v[108:111], v[28:31]
    v_mfma_f32_16x16x32_bf16 v[24:27], v[124:127], v[108:111], v[24:27]
    v_mfma_f32_16x16x32_bf16 v[0:3], v[124:127], v[104:107], v[0:3]
    v_mfma_f32_16x16x32_bf16 v[4:7], v[128:131], v[104:107], v[4:7]
    v_mfma_f32_16x16x32_bf16 v[8:11], v[132:135], v[104:107], v[8:11]
    v_mfma_f32_16x16x32_bf16 v[12:15], v[136:139], v[104:107], v[12:15]
    v_mfma_f32_16x16x32_bf16 v[16:19], v[104:107], v[140:143], v[16:19]
    v_mfma_f32_16x16x32_bf16 v[20:23], v[104:107], v[144:147], v[20:23]
    s_waitcnt lgkmcnt(0)
    v_mfma_f32_16x16x32_bf16 v[96:99], v[176:179], v[164:167], v[96:99]
    v_mfma_f32_16x16x32_bf16 v[100:103], v[180:183], v[164:167], v[100:103]
    s_barrier
    ds_read_b128 v[104:107], v196 offset:0
    v_mfma_f32_16x16x32_bf16 v[92:95], v[160:163], v[188:191], v[92:95]
    ds_read_b64_tr_b16 v[124:125], v208 offset:0
    v_mfma_f32_16x16x32_bf16 v[88:91], v[160:163], v[184:187], v[88:91]
    ds_read_b64_tr_b16 v[126:127], v208 offset:512
    v_mfma_f32_16x16x32_bf16 v[84:87], v[180:183], v[160:163], v[84:87]
    ds_read_b64_tr_b16 v[128:129], v209 offset:0
    v_mfma_f32_16x16x32_bf16 v[80:83], v[176:179], v[160:163], v[80:83]
    ds_read_b64_tr_b16 v[130:131], v209 offset:512
    v_mfma_f32_16x16x32_bf16 v[76:79], v[172:175], v[160:163], v[76:79]
    ds_read_b128 v[108:111], v196 offset:2048
    v_mfma_f32_16x16x32_bf16 v[72:75], v[168:171], v[160:163], v[72:75]
    ds_read_b64_tr_b16 v[132:133], v208 offset:8192
    v_mfma_f32_16x16x32_bf16 v[48:51], v[168:171], v[156:159], v[48:51]
    ds_read_b64_tr_b16 v[134:135], v208 offset:8704
    v_mfma_f32_16x16x32_bf16 v[52:55], v[172:175], v[156:159], v[52:55]
    ds_read_b64_tr_b16 v[136:137], v209 offset:8192
    v_mfma_f32_16x16x32_bf16 v[56:59], v[176:179], v[156:159], v[56:59]
    ds_read_b64_tr_b16 v[138:139], v209 offset:8704
    v_mfma_f32_16x16x32_bf16 v[60:63], v[180:183], v[156:159], v[60:63]
    ds_read_b128 v[112:115], v196 offset:4096
    v_mfma_f32_16x16x32_bf16 v[64:67], v[156:159], v[184:187], v[64:67]
    ds_read_b64_tr_b16 v[140:141], v208 offset:16384
    v_mfma_f32_16x16x32_bf16 v[68:71], v[156:159], v[188:191], v[68:71]
    ds_read_b64_tr_b16 v[142:143], v208 offset:16896
    v_mfma_f32_16x16x32_bf16 v[44:47], v[152:155], v[188:191], v[44:47]
    ds_read_b64_tr_b16 v[144:145], v209 offset:16384
    v_mfma_f32_16x16x32_bf16 v[40:43], v[152:155], v[184:187], v[40:43]
    ds_read_b64_tr_b16 v[146:147], v209 offset:16896
    v_mfma_f32_16x16x32_bf16 v[36:39], v[180:183], v[152:155], v[36:39]
    ds_read_b128 v[116:119], v196 offset:6144
    v_mfma_f32_16x16x32_bf16 v[32:35], v[176:179], v[152:155], v[32:35]
    ds_read_b128 v[120:123], v202
    v_mfma_f32_16x16x32_bf16 v[28:31], v[172:175], v[152:155], v[28:31]
    v_mfma_f32_16x16x32_bf16 v[24:27], v[168:171], v[152:155], v[24:27]
    v_mfma_f32_16x16x32_bf16 v[0:3], v[168:171], v[148:151], v[0:3]
    v_mfma_f32_16x16x32_bf16 v[4:7], v[172:175], v[148:151], v[4:7]
    v_mfma_f32_16x16x32_bf16 v[8:11], v[176:179], v[148:151], v[8:11]
    v_mfma_f32_16x16x32_bf16 v[12:15], v[180:183], v[148:151], v[12:15]
    v_mfma_f32_16x16x32_bf16 v[16:19], v[148:151], v[184:187], v[16:19]
    v_mfma_f32_16x16x32_bf16 v[20:23], v[148:151], v[188:191], v[20:23]
    s_waitcnt lgkmcnt(0)
    v_mfma_f32_16x16x32_bf16 v[96:99], v[132:135], v[120:123], v[96:99]
    ds_read_b128 v[148:151], v197 offset:0
    v_mfma_f32_16x16x32_bf16 v[100:103], v[136:139], v[120:123], v[100:103]
    ds_read_b64_tr_b16 v[168:169], v208 offset:4096
    v_mfma_f32_16x16x32_bf16 v[92:95], v[116:119], v[144:147], v[92:95]
    ds_read_b64_tr_b16 v[170:171], v208 offset:4608
    v_mfma_f32_16x16x32_bf16 v[88:91], v[116:119], v[140:143], v[88:91]
    ds_read_b64_tr_b16 v[172:173], v209 offset:4096
    v_mfma_f32_16x16x32_bf16 v[84:87], v[136:139], v[116:119], v[84:87]
    ds_read_b64_tr_b16 v[174:175], v209 offset:4608
    v_mfma_f32_16x16x32_bf16 v[80:83], v[132:135], v[116:119], v[80:83]
    ds_read_b128 v[152:155], v197 offset:2048
    v_mfma_f32_16x16x32_bf16 v[76:79], v[128:131], v[116:119], v[76:79]
    ds_read_b64_tr_b16 v[176:177], v208 offset:12288
    v_mfma_f32_16x16x32_bf16 v[72:75], v[124:127], v[116:119], v[72:75]
    ds_read_b64_tr_b16 v[178:179], v208 offset:12800
    v_mfma_f32_16x16x32_bf16 v[48:51], v[124:127], v[112:115], v[48:51]
    ds_read_b64_tr_b16 v[180:181], v209 offset:12288
    v_mfma_f32_16x16x32_bf16 v[52:55], v[128:131], v[112:115], v[52:55]
    ds_read_b64_tr_b16 v[182:183], v209 offset:12800
    v_mfma_f32_16x16x32_bf16 v[56:59], v[132:135], v[112:115], v[56:59]
    ds_read_b128 v[156:159], v197 offset:4096
    v_mfma_f32_16x16x32_bf16 v[60:63], v[136:139], v[112:115], v[60:63]
    ds_read_b64_tr_b16 v[184:185], v208 offset:20480
    v_mfma_f32_16x16x32_bf16 v[64:67], v[112:115], v[140:143], v[64:67]
    ds_read_b64_tr_b16 v[186:187], v208 offset:20992
    v_mfma_f32_16x16x32_bf16 v[68:71], v[112:115], v[144:147], v[68:71]
    ds_read_b64_tr_b16 v[188:189], v209 offset:20480
    v_mfma_f32_16x16x32_bf16 v[44:47], v[108:111], v[144:147], v[44:47]
    ds_read_b64_tr_b16 v[190:191], v209 offset:20992
    v_mfma_f32_16x16x32_bf16 v[40:43], v[108:111], v[140:143], v[40:43]
    ds_read_b128 v[160:163], v197 offset:6144
    v_mfma_f32_16x16x32_bf16 v[36:39], v[136:139], v[108:111], v[36:39]
    ds_read_b128 v[164:167], v203
    v_mfma_f32_16x16x32_bf16 v[32:35], v[132:135], v[108:111], v[32:35]
    v_mfma_f32_16x16x32_bf16 v[28:31], v[128:131], v[108:111], v[28:31]
    v_mfma_f32_16x16x32_bf16 v[24:27], v[124:127], v[108:111], v[24:27]
    v_mfma_f32_16x16x32_bf16 v[0:3], v[124:127], v[104:107], v[0:3]
    v_mfma_f32_16x16x32_bf16 v[4:7], v[128:131], v[104:107], v[4:7]
    v_mfma_f32_16x16x32_bf16 v[8:11], v[132:135], v[104:107], v[8:11]
    v_mfma_f32_16x16x32_bf16 v[12:15], v[136:139], v[104:107], v[12:15]
    v_mfma_f32_16x16x32_bf16 v[16:19], v[104:107], v[140:143], v[16:19]
    v_mfma_f32_16x16x32_bf16 v[20:23], v[104:107], v[144:147], v[20:23]
    s_waitcnt lgkmcnt(0)
    v_mfma_f32_16x16x32_bf16 v[96:99], v[176:179], v[164:167], v[96:99]
    v_mfma_f32_16x16x32_bf16 v[100:103], v[180:183], v[164:167], v[100:103]
    s_barrier
    ds_read_b128 v[104:107], v192 offset:0
    v_mfma_f32_16x16x32_bf16 v[92:95], v[160:163], v[188:191], v[92:95]
    ds_read_b64_tr_b16 v[124:125], v204 offset:0
    v_mfma_f32_16x16x32_bf16 v[88:91], v[160:163], v[184:187], v[88:91]
    ds_read_b64_tr_b16 v[126:127], v204 offset:512
    v_mfma_f32_16x16x32_bf16 v[84:87], v[180:183], v[160:163], v[84:87]
    ds_read_b64_tr_b16 v[128:129], v205 offset:0
    v_mfma_f32_16x16x32_bf16 v[80:83], v[176:179], v[160:163], v[80:83]
    ds_read_b64_tr_b16 v[130:131], v205 offset:512
    v_mfma_f32_16x16x32_bf16 v[76:79], v[172:175], v[160:163], v[76:79]
    ds_read_b128 v[108:111], v192 offset:2048
    v_mfma_f32_16x16x32_bf16 v[72:75], v[168:171], v[160:163], v[72:75]
    ds_read_b64_tr_b16 v[132:133], v204 offset:8192
    v_mfma_f32_16x16x32_bf16 v[48:51], v[168:171], v[156:159], v[48:51]
    ds_read_b64_tr_b16 v[134:135], v204 offset:8704
    v_mfma_f32_16x16x32_bf16 v[52:55], v[172:175], v[156:159], v[52:55]
    ds_read_b64_tr_b16 v[136:137], v205 offset:8192
    v_mfma_f32_16x16x32_bf16 v[56:59], v[176:179], v[156:159], v[56:59]
    ds_read_b64_tr_b16 v[138:139], v205 offset:8704
    v_mfma_f32_16x16x32_bf16 v[60:63], v[180:183], v[156:159], v[60:63]
    ds_read_b128 v[112:115], v192 offset:4096
    v_mfma_f32_16x16x32_bf16 v[64:67], v[156:159], v[184:187], v[64:67]
    ds_read_b64_tr_b16 v[140:141], v204 offset:16384
    v_mfma_f32_16x16x32_bf16 v[68:71], v[156:159], v[188:191], v[68:71]
    ds_read_b64_tr_b16 v[142:143], v204 offset:16896
    v_mfma_f32_16x16x32_bf16 v[44:47], v[152:155], v[188:191], v[44:47]
    ds_read_b64_tr_b16 v[144:145], v205 offset:16384
    v_mfma_f32_16x16x32_bf16 v[40:43], v[152:155], v[184:187], v[40:43]
    ds_read_b64_tr_b16 v[146:147], v205 offset:16896
    v_mfma_f32_16x16x32_bf16 v[36:39], v[180:183], v[152:155], v[36:39]
    ds_read_b128 v[116:119], v192 offset:6144
    v_mfma_f32_16x16x32_bf16 v[32:35], v[176:179], v[152:155], v[32:35]
    ds_read_b128 v[120:123], v198
    v_mfma_f32_16x16x32_bf16 v[28:31], v[172:175], v[152:155], v[28:31]
    v_mfma_f32_16x16x32_bf16 v[24:27], v[168:171], v[152:155], v[24:27]
    v_mfma_f32_16x16x32_bf16 v[0:3], v[168:171], v[148:151], v[0:3]
    v_mfma_f32_16x16x32_bf16 v[4:7], v[172:175], v[148:151], v[4:7]
    v_mfma_f32_16x16x32_bf16 v[8:11], v[176:179], v[148:151], v[8:11]
    v_mfma_f32_16x16x32_bf16 v[12:15], v[180:183], v[148:151], v[12:15]
    v_mfma_f32_16x16x32_bf16 v[16:19], v[148:151], v[184:187], v[16:19]
    v_mfma_f32_16x16x32_bf16 v[20:23], v[148:151], v[188:191], v[20:23]
    s_sub_u32 s40, s40, 1
    s_cmp_lg_u32 s40, 0
    s_cbranch_scc1 L_cl0
    s_waitcnt lgkmcnt(0)
    v_mfma_f32_16x16x32_bf16 v[96:99], v[132:135], v[120:123], v[96:99]
    ds_read_b128 v[148:151], v193 offset:0
    v_mfma_f32_16x16x32_bf16 v[100:103], v[136:139], v[120:123], v[100:103]
    ds_read_b64_tr_b16 v[168:169], v204 offset:4096
    v_mfma_f32_16x16x32_bf16 v[92:95], v[116:119], v[144:147], v[92:95]
    ds_read_b64_tr_b16 v[170:171], v204 offset:4608
    v_mfma_f32_16x16x32_bf16 v[88:91], v[116:119], v[140:143], v[88:91]
    ds_read_b64_tr_b16 v[172:173], v205 offset:4096
    v_mfma_f32_16x16x32_bf16 v[84:87], v[136:139], v[116:119], v[84:87]
    ds_read_b64_tr_b16 v[174:175], v205 offset:4608
    v_mfma_f32_16x16x32_bf16 v[80:83], v[132:135], v[116:119], v[80:83]
    ds_read_b128 v[152:155], v193 offset:2048
    v_mfma_f32_16x16x32_bf16 v[76:79], v[128:131], v[116:119], v[76:79]
    ds_read_b64_tr_b16 v[176:177], v204 offset:12288
    v_mfma_f32_16x16x32_bf16 v[72:75], v[124:127], v[116:119], v[72:75]
    ds_read_b64_tr_b16 v[178:179], v204 offset:12800
    v_mfma_f32_16x16x32_bf16 v[48:51], v[124:127], v[112:115], v[48:51]
    ds_read_b64_tr_b16 v[180:181], v205 offset:12288
    v_mfma_f32_16x16x32_bf16 v[52:55], v[128:131], v[112:115], v[52:55]
    ds_read_b64_tr_b16 v[182:183], v205 offset:12800
    v_mfma_f32_16x16x32_bf16 v[56:59], v[132:135], v[112:115], v[56:59]
    ds_read_b128 v[156:159], v193 offset:4096
    v_mfma_f32_16x16x32_bf16 v[60:63], v[136:139], v[112:115], v[60:63]
    ds_read_b64_tr_b16 v[184:185], v204 offset:20480
    v_mfma_f32_16x16x32_bf16 v[64:67], v[112:115], v[140:143], v[64:67]
    ds_read_b64_tr_b16 v[186:187], v204 offset:20992
    v_mfma_f32_16x16x32_bf16 v[68:71], v[112:115], v[144:147], v[68:71]
    ds_read_b64_tr_b16 v[188:189], v205 offset:20480
    v_mfma_f32_16x16x32_bf16 v[44:47], v[108:111], v[144:147], v[44:47]
    ds_read_b64_tr_b16 v[190:191], v205 offset:20992
    v_mfma_f32_16x16x32_bf16 v[40:43], v[108:111], v[140:143], v[40:43]
    ds_read_b128 v[160:163], v193 offset:6144
    v_mfma_f32_16x16x32_bf16 v[36:39], v[136:139], v[108:111], v[36:39]
    ds_read_b128 v[164:167], v199
    v_mfma_f32_16x16x32_bf16 v[32:35], v[132:135], v[108:111], v[32:35]
    v_mfma_f32_16x16x32_bf16 v[28:31], v[128:131], v[108:111], v[28:31]
    v_mfma_f32_16x16x32_bf16 v[24:27], v[124:127], v[108:111], v[24:27]
    v_mfma_f32_16x16x32_bf16 v[0:3], v[124:127], v[104:107], v[0:3]
    v_mfma_f32_16x16x32_bf16 v[4:7], v[128:131], v[104:107], v[4:7]
    v_mfma_f32_16x16x32_bf16 v[8:11], v[132:135], v[104:107], v[8:11]
    v_mfma_f32_16x16x32_bf16 v[12:15], v[136:139], v[104:107], v[12:15]
    v_mfma_f32_16x16x32_bf16 v[16:19], v[104:107], v[140:143], v[16:19]
    v_mfma_f32_16x16x32_bf16 v[20:23], v[104:107], v[144:147], v[20:23]
    s_waitcnt lgkmcnt(0)
    v_mfma_f32_16x16x32_bf16 v[96:99], v[176:179], v[164:167], v[96:99]
    v_mfma_f32_16x16x32_bf16 v[100:103], v[180:183], v[164:167], v[100:103]
    v_mfma_f32_16x16x32_bf16 v[92:95], v[160:163], v[188:191], v[92:95]
    v_mfma_f32_16x16x32_bf16 v[88:91], v[160:163], v[184:187], v[88:91]
    v_mfma_f32_16x16x32_bf16 v[84:87], v[180:183], v[160:163], v[84:87]
    v_mfma_f32_16x16x32_bf16 v[80:83], v[176:179], v[160:163], v[80:83]
    v_mfma_f32_16x16x32_bf16 v[76:79], v[172:175], v[160:163], v[76:79]
    v_mfma_f32_16x16x32_bf16 v[72:75], v[168:171], v[160:163], v[72:75]
    v_mfma_f32_16x16x32_bf16 v[48:51], v[168:171], v[156:159], v[48:51]
    v_mfma_f32_16x16x32_bf16 v[52:55], v[172:175], v[156:159], v[52:55]
    v_mfma_f32_16x16x32_bf16 v[56:59], v[176:179], v[156:159], v[56:59]
    v_mfma_f32_16x16x32_bf16 v[60:63], v[180:183], v[156:159], v[60:63]
    v_mfma_f32_16x16x32_bf16 v[64:67], v[156:159], v[184:187], v[64:67]
    v_mfma_f32_16x16x32_bf16 v[68:71], v[156:159], v[188:191], v[68:71]
    v_mfma_f32_16x16x32_bf16 v[44:47], v[152:155], v[188:191], v[44:47]
    v_mfma_f32_16x16x32_bf16 v[40:43], v[152:155], v[184:187], v[40:43]
    v_mfma_f32_16x16x32_bf16 v[36:39], v[180:183], v[152:155], v[36:39]
    v_mfma_f32_16x16x32_bf16 v[32:35], v[176:179], v[152:155], v[32:35]
    v_mfma_f32_16x16x32_bf16 v[28:31], v[172:175], v[152:155], v[28:31]
    v_mfma_f32_16x16x32_bf16 v[24:27], v[168:171], v[152:155], v[24:27]
    v_mfma_f32_16x16x32_bf16 v[0:3], v[168:171], v[148:151], v[0:3]
    v_mfma_f32_16x16x32_bf16 v[4:7], v[172:175], v[148:151], v[4:7]
    v_mfma_f32_16x16x32_bf16 v[8:11], v[176:179], v[148:151], v[8:11]
    v_mfma_f32_16x16x32_bf16 v[12:15], v[180:183], v[148:151], v[12:15]
    v_mfma_f32_16x16x32_bf16 v[16:19], v[148:151], v[184:187], v[16:19]
    v_mfma_f32_16x16x32_bf16 v[20:23], v[148:151], v[188:191], v[20:23]
    v_cvt_pk_bf16_f32 v104, v96, v97
    v_cvt_pk_bf16_f32 v105, v98, v99
    v_cvt_pk_bf16_f32 v106, v100, v101
    v_cvt_pk_bf16_f32 v107, v102, v103
    v_cvt_pk_bf16_f32 v120, v80, v81
    v_cvt_pk_bf16_f32 v121, v82, v83
    v_cvt_pk_bf16_f32 v122, v84, v85
    v_cvt_pk_bf16_f32 v123, v86, v87
    v_cvt_pk_bf16_f32 v148, v88, v89
    v_cvt_pk_bf16_f32 v149, v90, v91
    v_cvt_pk_bf16_f32 v158, v92, v93
    v_cvt_pk_bf16_f32 v159, v94, v95
    ds_write_b128 v214, v[120:123]
    ds_write_b64 v215, v[148:149] offset:1024
    ds_write_b64 v215, v[158:159] offset:1536
    ds_write_b32 v223, v224
    v_cvt_pk_bf16_f32 v136, v72, v73
    v_cvt_pk_bf16_f32 v137, v74, v75
    v_cvt_pk_bf16_f32 v138, v76, v77
    v_cvt_pk_bf16_f32 v139, v78, v79
    v_cvt_pk_bf16_f32 v116, v56, v57
    v_cvt_pk_bf16_f32 v117, v58, v59
    v_cvt_pk_bf16_f32 v118, v60, v61
    v_cvt_pk_bf16_f32 v119, v62, v63
    v_mfma_f32_16x16x32_bf16 v[188:191], v[120:123], v[136:139], v[232:235]
    s_nop 0
    v_mfma_f32_16x16x32_bf16 v[184:187], v[116:119], v[136:139], v[228:231]
    v_cvt_pk_bf16_f32 v132, v48, v49
    v_cvt_pk_bf16_f32 v133, v50, v51
    v_cvt_pk_bf16_f32 v134, v52, v53
    v_cvt_pk_bf16_f32 v135, v54, v55
    v_cvt_pk_bf16_f32 v112, v32, v33
    v_cvt_pk_bf16_f32 v113, v34, v35
    v_cvt_pk_bf16_f32 v114, v36, v37
    v_cvt_pk_bf16_f32 v115, v38, v39
    v_mfma_f32_16x16x32_bf16 v[180:183], v[116:119], v[132:135], v[232:235]
    s_nop 0
    v_mfma_f32_16x16x32_bf16 v[176:179], v[112:115], v[132:135], v[228:231]
    v_cvt_pk_bf16_f32 v128, v24, v25
    v_cvt_pk_bf16_f32 v129, v26, v27
    v_cvt_pk_bf16_f32 v130, v28, v29
    v_cvt_pk_bf16_f32 v131, v30, v31
    v_cvt_pk_bf16_f32 v108, v8, v9
    v_cvt_pk_bf16_f32 v109, v10, v11
    v_cvt_pk_bf16_f32 v110, v12, v13
    v_cvt_pk_bf16_f32 v111, v14, v15
    v_mfma_f32_16x16x32_bf16 v[172:175], v[112:115], v[128:131], v[232:235]
    s_nop 0
    v_mfma_f32_16x16x32_bf16 v[168:171], v[108:111], v[128:131], v[228:231]
    v_cvt_pk_bf16_f32 v124, v0, v1
    v_cvt_pk_bf16_f32 v125, v2, v3
    v_cvt_pk_bf16_f32 v126, v4, v5
    v_cvt_pk_bf16_f32 v127, v6, v7
    s_nop 1
    v_mfma_f32_16x16x32_bf16 v[164:167], v[108:111], v[124:127], v[232:235]
    v_cvt_pk_bf16_f32 v146, v64, v65
    v_cvt_pk_bf16_f32 v147, v66, v67
    v_cvt_pk_bf16_f32 v156, v68, v69
    v_cvt_pk_bf16_f32 v157, v70, v71
    v_cvt_pk_bf16_f32 v144, v40, v41
    v_cvt_pk_bf16_f32 v145, v42, v43
    v_cvt_pk_bf16_f32 v154, v44, v45
    v_cvt_pk_bf16_f32 v155, v46, v47
    v_cvt_pk_bf16_f32 v142, v16, v17
    v_cvt_pk_bf16_f32 v143, v18, v19
    v_cvt_pk_bf16_f32 v152, v20, v21
    v_cvt_pk_bf16_f32 v153, v22, v23
    s_mov_b32 s41, 0x3e3504f3
    s_mov_b32 s42, 0x3fb8aa3b
    s_mov_b32 s43, 0xffff0000
    v_max_f32 v12, v184, v185
    v_max_f32 v13, v186, v187
    v_max_f32 v14, v188, v189
    v_max_f32 v15, v190, v191
    v_max_f32 v8, v176, v177
    v_max_f32 v9, v178, v179
    v_max_f32 v10, v180, v181
    v_max_f32 v11, v182, v183
    v_max_f32 v4, v168, v169
    v_max_f32 v5, v170, v171
    v_max_f32 v6, v172, v173
    v_max_f32 v7, v174, v175
    v_cvt_pk_bf16_f32 v22, v12, v13
    v_cvt_pk_bf16_f32 v23, v14, v15
    v_cvt_pk_bf16_f32 v20, v8, v9
    v_cvt_pk_bf16_f32 v21, v10, v11
    v_cvt_pk_bf16_f32 v18, v4, v5
    v_cvt_pk_bf16_f32 v19, v6, v7
    v_lshlrev_b32 v12, 16, v22
    v_and_b32 v13, s43, v22
    v_lshlrev_b32 v14, 16, v23
    v_and_b32 v15, s43, v23
    v_lshlrev_b32 v8, 16, v20
    v_and_b32 v9, s43, v20
    v_lshlrev_b32 v10, 16, v21
    v_and_b32 v11, s43, v21
    v_lshlrev_b32 v4, 16, v18
    v_and_b32 v5, s43, v18
    v_lshlrev_b32 v6, 16, v19
    v_and_b32 v7, s43, v19
    v_pk_mul_f32 v[12:13], v[12:13], s[40:41] op_sel:[0,1] op_sel_hi:[1,1]
    v_pk_mul_f32 v[14:15], v[14:15], s[40:41] op_sel:[0,1] op_sel_hi:[1,1]
    v_pk_mul_f32 v[8:9], v[8:9], s[40:41] op_sel:[0,1] op_sel_hi:[1,1]
    v_pk_mul_f32 v[10:11], v[10:11], s[40:41] op_sel:[0,1] op_sel_hi:[1,1]
    v_pk_mul_f32 v[4:5], v[4:5], s[40:41] op_sel:[0,1] op_sel_hi:[1,1]
    v_pk_mul_f32 v[6:7], v[6:7], s[40:41] op_sel:[0,1] op_sel_hi:[1,1]
    v_cvt_pk_bf16_f32 v22, v12, v13
    v_cvt_pk_bf16_f32 v23, v14, v15
    v_cvt_pk_bf16_f32 v20, v8, v9
    v_cvt_pk_bf16_f32 v21, v10, v11
    v_cvt_pk_bf16_f32 v18, v4, v5
    v_cvt_pk_bf16_f32 v19, v6, v7
    v_lshlrev_b32 v12, 16, v22
    v_and_b32 v13, s43, v22
    v_lshlrev_b32 v14, 16, v23
    v_and_b32 v15, s43, v23
    v_lshlrev_b32 v8, 16, v20
    v_and_b32 v9, s43, v20
    v_lshlrev_b32 v10, 16, v21
    v_and_b32 v11, s43, v21
    v_lshlrev_b32 v4, 16, v18
    v_and_b32 v5, s43, v18
    v_lshlrev_b32 v6, 16, v19
    v_and_b32 v7, s43, v19
L_ex_41:
    ds_read_b32 v216, v223 offset:4
    s_waitcnt lgkmcnt(0)
    v_readfirstlane_b32 s44, v216
    s_nop 0
    s_cmp_eq_u32 s44, 0
    s_cbranch_scc1 L_ex_41
    ds_read_b64 v[140:141], v215 offset:2048
    ds_read_b64 v[150:151], v215 offset:2560
    s_branch L_attn
L_c1:
    s_barrier
    ds_read_b128 v[104:107], v192 offset:0
    ds_read_b64_tr_b16 v[124:125], v204 offset:0
    ds_read_b64_tr_b16 v[126:127], v204 offset:512
    ds_read_b64_tr_b16 v[128:129], v205 offset:0
    ds_read_b64_tr_b16 v[130:131], v205 offset:512
    ds_read_b128 v[108:111], v192 offset:2048
    ds_read_b64_tr_b16 v[132:133], v204 offset:8192
    ds_read_b64_tr_b16 v[134:135], v204 offset:8704
    ds_read_b64_tr_b16 v[136:137], v205 offset:8192
    ds_read_b64_tr_b16 v[138:139], v205 offset:8704
    ds_read_b128 v[112:115], v192 offset:4096
    ds_read_b64_tr_b16 v[140:141], v204 offset:16384
    ds_read_b64_tr_b16 v[142:143], v204 offset:16896
    ds_read_b64_tr_b16 v[144:145], v205 offset:16384
    ds_read_b64_tr_b16 v[146:147], v205 offset:16896
    ds_read_b128 v[116:119], v192 offset:6144
    ds_read_b128 v[120:123], v198
    s_mov_b32 s40, 5
L_cl1:
    s_waitcnt lgkmcnt(0)
    v_mfma_f32_16x16x32_bf16 v[96:99], v[120:123], v[140:143], v[96:99]
    ds_read_b128 v[148:151], v193 offset:0
    v_mfma_f32_16x16x32_bf16 v[100:103], v[120:123], v[144:147], v[100:103]
    ds_read_b64_tr_b16 v[168:169], v204 offset:4096
    v_mfma_f32_16x16x32_bf16 v[92:95], v[116:119], v[144:147], v[92:95]
    ds_read_b64_tr_b16 v[170:171], v204 offset:4608
    v_mfma_f32_16x16x32_bf16 v[88:91], v[116:119], v[140:143], v[88:91]
    ds_read_b64_tr_b16 v[172:173], v205 offset:4096
    v_mfma_f32_16x16x32_bf16 v[84:87], v[136:139], v[116:119], v[84:87]
    ds_read_b64_tr_b16 v[174:175], v205 offset:4608
    v_mfma_f32_16x16x32_bf16 v[80:83], v[132:135], v[116:119], v[80:83]
    ds_read_b128 v[152:155], v193 offset:2048
    v_mfma_f32_16x16x32_bf16 v[76:79], v[128:131], v[116:119], v[76:79]
    ds_read_b64_tr_b16 v[176:177], v204 offset:12288
    v_mfma_f32_16x16x32_bf16 v[72:75], v[124:127], v[116:119], v[72:75]
    ds_read_b64_tr_b16 v[178:179], v204 offset:12800
    v_mfma_f32_16x16x32_bf16 v[48:51], v[124:127], v[112:115], v[48:51]
    ds_read_b64_tr_b16 v[180:181], v205 offset:12288
    v_mfma_f32_16x16x32_bf16 v[52:55], v[128:131], v[112:115], v[52:55]
    ds_read_b64_tr_b16 v[182:183], v205 offset:12800
    v_mfma_f32_16x16x32_bf16 v[56:59], v[132:135], v[112:115], v[56:59]
    ds_read_b128 v[156:159], v193 offset:4096
    v_mfma_f32_16x16x32_bf16 v[60:63], v[136:139], v[112:115], v[60:63]
    ds_read_b64_tr_b16 v[184:185], v204 offset:20480
    v_mfma_f32_16x16x32_bf16 v[64:67], v[112:115], v[140:143], v[64:67]
    ds_read_b64_tr_b16 v[186:187], v204 offset:20992
    v_mfma_f32_16x16x32_bf16 v[68:71], v[112:115], v[144:147], v[68:71]
    ds_read_b64_tr_b16 v[188:189], v205 offset:20480
    v_mfma_f32_16x16x32_bf16 v[44:47], v[108:111], v[144:147], v[44:47]
    ds_read_b64_tr_b16 v[190:191], v205 offset:20992
    v_mfma_f32_16x16x32_bf16 v[40:43], v[108:111], v[140:143], v[40:43]
    ds_read_b128 v[160:163], v193 offset:6144
    v_mfma_f32_16x16x32_bf16 v[36:39], v[136:139], v[108:111], v[36:39]
    ds_read_b128 v[164:167], v199
    v_mfma_f32_16x16x32_bf16 v[32:35], v[132:135], v[108:111], v[32:35]
    v_mfma_f32_16x16x32_bf16 v[28:31], v[128:131], v[108:111], v[28:31]
    v_mfma_f32_16x16x32_bf16 v[24:27], v[124:127], v[108:111], v[24:27]
    v_mfma_f32_16x16x32_bf16 v[0:3], v[124:127], v[104:107], v[0:3]
    v_mfma_f32_16x16x32_bf16 v[4:7], v[128:131], v[104:107], v[4:7]
    v_mfma_f32_16x16x32_bf16 v[8:11], v[132:135], v[104:107], v[8:11]
    v_mfma_f32_16x16x32_bf16 v[12:15], v[136:139], v[104:107], v[12:15]
    v_mfma_f32_16x16x32_bf16 v[16:19], v[104:107], v[140:143], v[16:19]
    v_mfma_f32_16x16x32_bf16 v[20:23], v[104:107], v[144:147], v[20:23]
    s_waitcnt lgkmcnt(0)
    v_mfma_f32_16x16x32_bf16 v[96:99], v[164:167], v[184:187], v[96:99]
    v_mfma_f32_16x16x32_bf16 v[100:103], v[164:167], v[188:191], v[100:103]
    s_barrier
    ds_read_b128 v[104:107], v194 offset:0
    v_mfma_f32_16x16x32_bf16 v[92:95], v[160:163], v[188:191], v[92:95]
    ds_read_b64_tr_b16 v[124:125], v206 offset:0
    v_mfma_f32_16x16x32_bf16 v[88:91], v[160:163], v[184:187], v[88:91]
    ds_read_b64_tr_b16 v[126:127], v206 offset:512
    v_mfma_f32_16x16x32_bf16 v[84:87], v[180:183], v[160:163], v[84:87]
    ds_read_b64_tr_b16 v[128:129], v207 offset:0
    v_mfma_f32_16x16x32_bf16 v[80:83], v[176:179], v[160:163], v[80:83]
    ds_read_b64_tr_b16 v[130:131], v207 offset:512
    v_mfma_f32_16x16x32_bf16 v[76:79], v[172:175], v[160:163], v[76:79]
    ds_read_b128 v[108:111], v194 offset:2048
    v_mfma_f32_16x16x32_bf16 v[72:75], v[168:171], v[160:163], v[72:75]
    ds_read_b64_tr_b16 v[132:133], v206 offset:8192
    v_mfma_f32_16x16x32_bf16 v[48:51], v[168:171], v[156:159], v[48:51]
    ds_read_b64_tr_b16 v[134:135], v206 offset:8704
    v_mfma_f32_16x16x32_bf16 v[52:55], v[172:175], v[156:159], v[52:55]
    ds_read_b64_tr_b16 v[136:137], v207 offset:8192
    v_mfma_f32_16x16x32_bf16 v[56:59], v[176:179], v[156:159], v[56:59]
    ds_read_b64_tr_b16 v[138:139], v207 offset:8704
    v_mfma_f32_16x16x32_bf16 v[60:63], v[180:183], v[156:159], v[60:63]
    ds_read_b128 v[112:115], v194 offset:4096
    v_mfma_f32_16x16x32_bf16 v[64:67], v[156:159], v[184:187], v[64:67]
    ds_read_b64_tr_b16 v[140:141], v206 offset:16384
    v_mfma_f32_16x16x32_bf16 v[68:71], v[156:159], v[188:191], v[68:71]
    ds_read_b64_tr_b16 v[142:143], v206 offset:16896
    v_mfma_f32_16x16x32_bf16 v[44:47], v[152:155], v[188:191], v[44:47]
    ds_read_b64_tr_b16 v[144:145], v207 offset:16384
    v_mfma_f32_16x16x32_bf16 v[40:43], v[152:155], v[184:187], v[40:43]
    ds_read_b64_tr_b16 v[146:147], v207 offset:16896
    v_mfma_f32_16x16x32_bf16 v[36:39], v[180:183], v[152:155], v[36:39]
    ds_read_b128 v[116:119], v194 offset:6144
    v_mfma_f32_16x16x32_bf16 v[32:35], v[176:179], v[152:155], v[32:35]
    ds_read_b128 v[120:123], v200
    v_mfma_f32_16x16x32_bf16 v[28:31], v[172:175], v[152:155], v[28:31]
    v_mfma_f32_16x16x32_bf16 v[24:27], v[168:171], v[152:155], v[24:27]
    v_mfma_f32_16x16x32_bf16 v[0:3], v[168:171], v[148:151], v[0:3]
    v_mfma_f32_16x16x32_bf16 v[4:7], v[172:175], v[148:151], v[4:7]
    v_mfma_f32_16x16x32_bf16 v[8:11], v[176:179], v[148:151], v[8:11]
    v_mfma_f32_16x16x32_bf16 v[12:15], v[180:183], v[148:151], v[12:15]
    v_mfma_f32_16x16x32_bf16 v[16:19], v[148:151], v[184:187], v[16:19]
    v_mfma_f32_16x16x32_bf16 v[20:23], v[148:151], v[188:191], v[20:23]
    s_waitcnt lgkmcnt(0)
    v_mfma_f32_16x16x32_bf16 v[96:99], v[120:123], v[140:143], v[96:99]
    ds_read_b128 v[148:151], v195 offset:0
    v_mfma_f32_16x16x32_bf16 v[100:103], v[120:123], v[144:147], v[100:103]
    ds_read_b64_tr_b16 v[168:169], v206 offset:4096
    v_mfma_f32_16x16x32_bf16 v[92:95], v[116:119], v[144:147], v[92:95]
    ds_read_b64_tr_b16 v[170:171], v206 offset:4608
    v_mfma_f32_16x16x32_bf16 v[88:91], v[116:119], v[140:143], v[88:91]
    ds_read_b64_tr_b16 v[172:173], v207 offset:4096
    v_mfma_f32_16x16x32_bf16 v[84:87], v[136:139], v[116:119], v[84:87]
    ds_read_b64_tr_b16 v[174:175], v207 offset:4608
    v_mfma_f32_16x16x32_bf16 v[80:83], v[132:135], v[116:119], v[80:83]
    ds_read_b128 v[152:155], v195 offset:2048
    v_mfma_f32_16x16x32_bf16 v[76:79], v[128:131], v[116:119], v[76:79]
    ds_read_b64_tr_b16 v[176:177], v206 offset:12288
    v_mfma_f32_16x16x32_bf16 v[72:75], v[124:127], v[116:119], v[72:75]
    ds_read_b64_tr_b16 v[178:179], v206 offset:12800
    v_mfma_f32_16x16x32_bf16 v[48:51], v[124:127], v[112:115], v[48:51]
    ds_read_b64_tr_b16 v[180:181], v207 offset:12288
    v_mfma_f32_16x16x32_bf16 v[52:55], v[128:131], v[112:115], v[52:55]
    ds_read_b64_tr_b16 v[182:183], v207 offset:12800
    v_mfma_f32_16x16x32_bf16 v[56:59], v[132:135], v[112:115], v[56:59]
    ds_read_b128 v[156:159], v195 offset:4096
    v_mfma_f32_16x16x32_bf16 v[60:63], v[136:139], v[112:115], v[60:63]
    ds_read_b64_tr_b16 v[184:185], v206 offset:20480
    v_mfma_f32_16x16x32_bf16 v[64:67], v[112:115], v[140:143], v[64:67]
    ds_read_b64_tr_b16 v[186:187], v206 offset:20992
    v_mfma_f32_16x16x32_bf16 v[68:71], v[112:115], v[144:147], v[68:71]
    ds_read_b64_tr_b16 v[188:189], v207 offset:20480
    v_mfma_f32_16x16x32_bf16 v[44:47], v[108:111], v[144:147], v[44:47]
    ds_read_b64_tr_b16 v[190:191], v207 offset:20992
    v_mfma_f32_16x16x32_bf16 v[40:43], v[108:111], v[140:143], v[40:43]
    ds_read_b128 v[160:163], v195 offset:6144
    v_mfma_f32_16x16x32_bf16 v[36:39], v[136:139], v[108:111], v[36:39]
    ds_read_b128 v[164:167], v201
    v_mfma_f32_16x16x32_bf16 v[32:35], v[132:135], v[108:111], v[32:35]
    v_mfma_f32_16x16x32_bf16 v[28:31], v[128:131], v[108:111], v[28:31]
    v_mfma_f32_16x16x32_bf16 v[24:27], v[124:127], v[108:111], v[24:27]
    v_mfma_f32_16x16x32_bf16 v[0:3], v[124:127], v[104:107], v[0:3]
    v_mfma_f32_16x16x32_bf16 v[4:7], v[128:131], v[104:107], v[4:7]
    v_mfma_f32_16x16x32_bf16 v[8:11], v[132:135], v[104:107], v[8:11]
    v_mfma_f32_16x16x32_bf16 v[12:15], v[136:139], v[104:107], v[12:15]
    v_mfma_f32_16x16x32_bf16 v[16:19], v[104:107], v[140:143], v[16:19]
    v_mfma_f32_16x16x32_bf16 v[20:23], v[104:107], v[144:147], v[20:23]
    s_waitcnt lgkmcnt(0)
    v_mfma_f32_16x16x32_bf16 v[96:99], v[164:167], v[184:187], v[96:99]
    v_mfma_f32_16x16x32_bf16 v[100:103], v[164:167], v[188:191], v[100:103]
    s_barrier
    ds_read_b128 v[104:107], v196 offset:0
    v_mfma_f32_16x16x32_bf16 v[92:95], v[160:163], v[188:191], v[92:95]
    ds_read_b64_tr_b16 v[124:125], v208 offset:0
    v_mfma_f32_16x16x32_bf16 v[88:91], v[160:163], v[184:187], v[88:91]
    ds_read_b64_tr_b16 v[126:127], v208 offset:512
    v_mfma_f32_16x16x32_bf16 v[84:87], v[180:183], v[160:163], v[84:87]
    ds_read_b64_tr_b16 v[128:129], v209 offset:0
    v_mfma_f32_16x16x32_bf16 v[80:83], v[176:179], v[160:163], v[80:83]
    ds_read_b64_tr_b16 v[130:131], v209 offset:512
    v_mfma_f32_16x16x32_bf16 v[76:79], v[172:175], v[160:163], v[76:79]
    ds_read_b128 v[108:111], v196 offset:2048
    v_mfma_f32_16x16x32_bf16 v[72:75], v[168:171], v[160:163], v[72:75]
    ds_read_b64_tr_b16 v[132:133], v208 offset:8192
    v_mfma_f32_16x16x32_bf16 v[48:51], v[168:171], v[156:159], v[48:51]
    ds_read_b64_tr_b16 v[134:135], v208 offset:8704
    v_mfma_f32_16x16x32_bf16 v[52:55], v[172:175], v[156:159], v[52:55]
    ds_read_b64_tr_b16 v[136:137], v209 offset:8192
    v_mfma_f32_16x16x32_bf16 v[56:59], v[176:179], v[156:159], v[56:59]
    ds_read_b64_tr_b16 v[138:139], v209 offset:8704
    v_mfma_f32_16x16x32_bf16 v[60:63], v[180:183], v[156:159], v[60:63]
    ds_read_b128 v[112:115], v196 offset:4096
    v_mfma_f32_16x16x32_bf16 v[64:67], v[156:159], v[184:187], v[64:67]
    ds_read_b64_tr_b16 v[140:141], v208 offset:16384
    v_mfma_f32_16x16x32_bf16 v[68:71], v[156:159], v[188:191], v[68:71]
    ds_read_b64_tr_b16 v[142:143], v208 offset:16896
    v_mfma_f32_16x16x32_bf16 v[44:47], v[152:155], v[188:191], v[44:47]
    ds_read_b64_tr_b16 v[144:145], v209 offset:16384
    v_mfma_f32_16x16x32_bf16 v[40:43], v[152:155], v[184:187], v[40:43]
    ds_read_b64_tr_b16 v[146:147], v209 offset:16896
    v_mfma_f32_16x16x32_bf16 v[36:39], v[180:183], v[152:155], v[36:39]
    ds_read_b128 v[116:119], v196 offset:6144
    v_mfma_f32_16x16x32_bf16 v[32:35], v[176:179], v[152:155], v[32:35]
    ds_read_b128 v[120:123], v202
    v_mfma_f32_16x16x32_bf16 v[28:31], v[172:175], v[152:155], v[28:31]
    v_mfma_f32_16x16x32_bf16 v[24:27], v[168:171], v[152:155], v[24:27]
    v_mfma_f32_16x16x32_bf16 v[0:3], v[168:171], v[148:151], v[0:3]
    v_mfma_f32_16x16x32_bf16 v[4:7], v[172:175], v[148:151], v[4:7]
    v_mfma_f32_16x16x32_bf16 v[8:11], v[176:179], v[148:151], v[8:11]
    v_mfma_f32_16x16x32_bf16 v[12:15], v[180:183], v[148:151], v[12:15]
    v_mfma_f32_16x16x32_bf16 v[16:19], v[148:151], v[184:187], v[16:19]
    v_mfma_f32_16x16x32_bf16 v[20:23], v[148:151], v[188:191], v[20:23]
    s_waitcnt lgkmcnt(0)
    v_mfma_f32_16x16x32_bf16 v[96:99], v[120:123], v[140:143], v[96:99]
    ds_read_b128 v[148:151], v197 offset:0
    v_mfma_f32_16x16x32_bf16 v[100:103], v[120:123], v[144:147], v[100:103]
    ds_read_b64_tr_b16 v[168:169], v208 offset:4096
    v_mfma_f32_16x16x32_bf16 v[92:95], v[116:119], v[144:147], v[92:95]
    ds_read_b64_tr_b16 v[170:171], v208 offset:4608
    v_mfma_f32_16x16x32_bf16 v[88:91], v[116:119], v[140:143], v[88:91]
    ds_read_b64_tr_b16 v[172:173], v209 offset:4096
    v_mfma_f32_16x16x32_bf16 v[84:87], v[136:139], v[116:119], v[84:87]
    ds_read_b64_tr_b16 v[174:175], v209 offset:4608
    v_mfma_f32_16x16x32_bf16 v[80:83], v[132:135], v[116:119], v[80:83]
    ds_read_b128 v[152:155], v197 offset:2048
    v_mfma_f32_16x16x32_bf16 v[76:79], v[128:131], v[116:119], v[76:79]
    ds_read_b64_tr_b16 v[176:177], v208 offset:12288
    v_mfma_f32_16x16x32_bf16 v[72:75], v[124:127], v[116:119], v[72:75]
    ds_read_b64_tr_b16 v[178:179], v208 offset:12800
    v_mfma_f32_16x16x32_bf16 v[48:51], v[124:127], v[112:115], v[48:51]
    ds_read_b64_tr_b16 v[180:181], v209 offset:12288
    v_mfma_f32_16x16x32_bf16 v[52:55], v[128:131], v[112:115], v[52:55]
    ds_read_b64_tr_b16 v[182:183], v209 offset:12800
    v_mfma_f32_16x16x32_bf16 v[56:59], v[132:135], v[112:115], v[56:59]
    ds_read_b128 v[156:159], v197 offset:4096
    v_mfma_f32_16x16x32_bf16 v[60:63], v[136:139], v[112:115], v[60:63]
    ds_read_b64_tr_b16 v[184:185], v208 offset:20480
    v_mfma_f32_16x16x32_bf16 v[64:67], v[112:115], v[140:143], v[64:67]
    ds_read_b64_tr_b16 v[186:187], v208 offset:20992
    v_mfma_f32_16x16x32_bf16 v[68:71], v[112:115], v[144:147], v[68:71]
    ds_read_b64_tr_b16 v[188:189], v209 offset:20480
    v_mfma_f32_16x16x32_bf16 v[44:47], v[108:111], v[144:147], v[44:47]
    ds_read_b64_tr_b16 v[190:191], v209 offset:20992
    v_mfma_f32_16x16x32_bf16 v[40:43], v[108:111], v[140:143], v[40:43]
    ds_read_b128 v[160:163], v197 offset:6144
    v_mfma_f32_16x16x32_bf16 v[36:39], v[136:139], v[108:111], v[36:39]
    ds_read_b128 v[164:167], v203
    v_mfma_f32_16x16x32_bf16 v[32:35], v[132:135], v[108:111], v[32:35]
    v_mfma_f32_16x16x32_bf16 v[28:31], v[128:131], v[108:111], v[28:31]
    v_mfma_f32_16x16x32_bf16 v[24:27], v[124:127], v[108:111], v[24:27]
    v_mfma_f32_16x16x32_bf16 v[0:3], v[124:127], v[104:107], v[0:3]
    v_mfma_f32_16x16x32_bf16 v[4:7], v[128:131], v[104:107], v[4:7]
    v_mfma_f32_16x16x32_bf16 v[8:11], v[132:135], v[104:107], v[8:11]
    v_mfma_f32_16x16x32_bf16 v[12:15], v[136:139], v[104:107], v[12:15]
    v_mfma_f32_16x16x32_bf16 v[16:19], v[104:107], v[140:143], v[16:19]
    v_mfma_f32_16x16x32_bf16 v[20:23], v[104:107], v[144:147], v[20:23]
    s_waitcnt lgkmcnt(0)
    v_mfma_f32_16x16x32_bf16 v[96:99], v[164:167], v[184:187], v[96:99]
    v_mfma_f32_16x16x32_bf16 v[100:103], v[164:167], v[188:191], v[100:103]
    s_barrier
    ds_read_b128 v[104:107], v192 offset:0
    v_mfma_f32_16x16x32_bf16 v[92:95], v[160:163], v[188:191], v[92:95]
    ds_read_b64_tr_b16 v[124:125], v204 offset:0
    v_mfma_f32_16x16x32_bf16 v[88:91], v[160:163], v[184:187], v[88:91]
    ds_read_b64_tr_b16 v[126:127], v204 offset:512
    v_mfma_f32_16x16x32_bf16 v[84:87], v[180:183], v[160:163], v[84:87]
    ds_read_b64_tr_b16 v[128:129], v205 offset:0
    v_mfma_f32_16x16x32_bf16 v[80:83], v[176:179], v[160:163], v[80:83]
    ds_read_b64_tr_b16 v[130:131], v205 offset:512
    v_mfma_f32_16x16x32_bf16 v[76:79], v[172:175], v[160:163], v[76:79]
    ds_read_b128 v[108:111], v192 offset:2048
    v_mfma_f32_16x16x32_bf16 v[72:75], v[168:171], v[160:163], v[72:75]
    ds_read_b64_tr_b16 v[132:133], v204 offset:8192
    v_mfma_f32_16x16x32_bf16 v[48:51], v[168:171], v[156:159], v[48:51]
    ds_read_b64_tr_b16 v[134:135], v204 offset:8704
    v_mfma_f32_16x16x32_bf16 v[52:55], v[172:175], v[156:159], v[52:55]
    ds_read_b64_tr_b16 v[136:137], v205 offset:8192
    v_mfma_f32_16x16x32_bf16 v[56:59], v[176:179], v[156:159], v[56:59]
    ds_read_b64_tr_b16 v[138:139], v205 offset:8704
    v_mfma_f32_16x16x32_bf16 v[60:63], v[180:183], v[156:159], v[60:63]
    ds_read_b128 v[112:115], v192 offset:4096
    v_mfma_f32_16x16x32_bf16 v[64:67], v[156:159], v[184:187], v[64:67]
    ds_read_b64_tr_b16 v[140:141], v204 offset:16384
    v_mfma_f32_16x16x32_bf16 v[68:71], v[156:159], v[188:191], v[68:71]
    ds_read_b64_tr_b16 v[142:143], v204 offset:16896
    v_mfma_f32_16x16x32_bf16 v[44:47], v[152:155], v[188:191], v[44:47]
    ds_read_b64_tr_b16 v[144:145], v205 offset:16384
    v_mfma_f32_16x16x32_bf16 v[40:43], v[152:155], v[184:187], v[40:43]
    ds_read_b64_tr_b16 v[146:147], v205 offset:16896
    v_mfma_f32_16x16x32_bf16 v[36:39], v[180:183], v[152:155], v[36:39]
    ds_read_b128 v[116:119], v192 offset:6144
    v_mfma_f32_16x16x32_bf16 v[32:35], v[176:179], v[152:155], v[32:35]
    ds_read_b128 v[120:123], v198
    v_mfma_f32_16x16x32_bf16 v[28:31], v[172:175], v[152:155], v[28:31]
    v_mfma_f32_16x16x32_bf16 v[24:27], v[168:171], v[152:155], v[24:27]
    v_mfma_f32_16x16x32_bf16 v[0:3], v[168:171], v[148:151], v[0:3]
    v_mfma_f32_16x16x32_bf16 v[4:7], v[172:175], v[148:151], v[4:7]
    v_mfma_f32_16x16x32_bf16 v[8:11], v[176:179], v[148:151], v[8:11]
    v_mfma_f32_16x16x32_bf16 v[12:15], v[180:183], v[148:151], v[12:15]
    v_mfma_f32_16x16x32_bf16 v[16:19], v[148:151], v[184:187], v[16:19]
    v_mfma_f32_16x16x32_bf16 v[20:23], v[148:151], v[188:191], v[20:23]
    s_sub_u32 s40, s40, 1
    s_cmp_lg_u32 s40, 0
    s_cbranch_scc1 L_cl1
    s_waitcnt lgkmcnt(0)
    v_mfma_f32_16x16x32_bf16 v[96:99], v[120:123], v[140:143], v[96:99]
    ds_read_b128 v[148:151], v193 offset:0
    v_mfma_f32_16x16x32_bf16 v[100:103], v[120:123], v[144:147], v[100:103]
    ds_read_b64_tr_b16 v[168:169], v204 offset:4096
    v_mfma_f32_16x16x32_bf16 v[92:95], v[116:119], v[144:147], v[92:95]
    ds_read_b64_tr_b16 v[170:171], v204 offset:4608
    v_mfma_f32_16x16x32_bf16 v[88:91], v[116:119], v[140:143], v[88:91]
    ds_read_b64_tr_b16 v[172:173], v205 offset:4096
    v_mfma_f32_16x16x32_bf16 v[84:87], v[136:139], v[116:119], v[84:87]
    ds_read_b64_tr_b16 v[174:175], v205 offset:4608
    v_mfma_f32_16x16x32_bf16 v[80:83], v[132:135], v[116:119], v[80:83]
    ds_read_b128 v[152:155], v193 offset:2048
    v_mfma_f32_16x16x32_bf16 v[76:79], v[128:131], v[116:119], v[76:79]
    ds_read_b64_tr_b16 v[176:177], v204 offset:12288
    v_mfma_f32_16x16x32_bf16 v[72:75], v[124:127], v[116:119], v[72:75]
    ds_read_b64_tr_b16 v[178:179], v204 offset:12800
    v_mfma_f32_16x16x32_bf16 v[48:51], v[124:127], v[112:115], v[48:51]
    ds_read_b64_tr_b16 v[180:181], v205 offset:12288
    v_mfma_f32_16x16x32_bf16 v[52:55], v[128:131], v[112:115], v[52:55]
    ds_read_b64_tr_b16 v[182:183], v205 offset:12800
    v_mfma_f32_16x16x32_bf16 v[56:59], v[132:135], v[112:115], v[56:59]
    ds_read_b128 v[156:159], v193 offset:4096
    v_mfma_f32_16x16x32_bf16 v[60:63], v[136:139], v[112:115], v[60:63]
    ds_read_b64_tr_b16 v[184:185], v204 offset:20480
    v_mfma_f32_16x16x32_bf16 v[64:67], v[112:115], v[140:143], v[64:67]
    ds_read_b64_tr_b16 v[186:187], v204 offset:20992
    v_mfma_f32_16x16x32_bf16 v[68:71], v[112:115], v[144:147], v[68:71]
    ds_read_b64_tr_b16 v[188:189], v205 offset:20480
    v_mfma_f32_16x16x32_bf16 v[44:47], v[108:111], v[144:147], v[44:47]
    ds_read_b64_tr_b16 v[190:191], v205 offset:20992
    v_mfma_f32_16x16x32_bf16 v[40:43], v[108:111], v[140:143], v[40:43]
    ds_read_b128 v[160:163], v193 offset:6144
    v_mfma_f32_16x16x32_bf16 v[36:39], v[136:139], v[108:111], v[36:39]
    ds_read_b128 v[164:167], v199
    v_mfma_f32_16x16x32_bf16 v[32:35], v[132:135], v[108:111], v[32:35]
    v_mfma_f32_16x16x32_bf16 v[28:31], v[128:131], v[108:111], v[28:31]
    v_mfma_f32_16x16x32_bf16 v[24:27], v[124:127], v[108:111], v[24:27]
    v_mfma_f32_16x16x32_bf16 v[0:3], v[124:127], v[104:107], v[0:3]
    v_mfma_f32_16x16x32_bf16 v[4:7], v[128:131], v[104:107], v[4:7]
    v_mfma_f32_16x16x32_bf16 v[8:11], v[132:135], v[104:107], v[8:11]
    v_mfma_f32_16x16x32_bf16 v[12:15], v[136:139], v[104:107], v[12:15]
    v_mfma_f32_16x16x32_bf16 v[16:19], v[104:107], v[140:143], v[16:19]
    v_mfma_f32_16x16x32_bf16 v[20:23], v[104:107], v[144:147], v[20:23]
    s_waitcnt lgkmcnt(0)
    v_mfma_f32_16x16x32_bf16 v[96:99], v[164:167], v[184:187], v[96:99]
    v_mfma_f32_16x16x32_bf16 v[100:103], v[164:167], v[188:191], v[100:103]
    v_mfma_f32_16x16x32_bf16 v[92:95], v[160:163], v[188:191], v[92:95]
    v_mfma_f32_16x16x32_bf16 v[88:91], v[160:163], v[184:187], v[88:91]
    v_mfma_f32_16x16x32_bf16 v[84:87], v[180:183], v[160:163], v[84:87]
    v_mfma_f32_16x16x32_bf16 v[80:83], v[176:179], v[160:163], v[80:83]
    v_mfma_f32_16x16x32_bf16 v[76:79], v[172:175], v[160:163], v[76:79]
    v_mfma_f32_16x16x32_bf16 v[72:75], v[168:171], v[160:163], v[72:75]
    v_mfma_f32_16x16x32_bf16 v[48:51], v[168:171], v[156:159], v[48:51]
    v_mfma_f32_16x16x32_bf16 v[52:55], v[172:175], v[156:159], v[52:55]
    v_mfma_f32_16x16x32_bf16 v[56:59], v[176:179], v[156:159], v[56:59]
    v_mfma_f32_16x16x32_bf16 v[60:63], v[180:183], v[156:159], v[60:63]
    v_mfma_f32_16x16x32_bf16 v[64:67], v[156:159], v[184:187], v[64:67]
    v_mfma_f32_16x16x32_bf16 v[68:71], v[156:159], v[188:191], v[68:71]
    v_mfma_f32_16x16x32_bf16 v[44:47], v[152:155], v[188:191], v[44:47]
    v_mfma_f32_16x16x32_bf16 v[40:43], v[152:155], v[184:187], v[40:43]
    v_mfma_f32_16x16x32_bf16 v[36:39], v[180:183], v[152:155], v[36:39]
    v_mfma_f32_16x16x32_bf16 v[32:35], v[176:179], v[152:155], v[32:35]
    v_mfma_f32_16x16x32_bf16 v[28:31], v[172:175], v[152:155], v[28:31]
    v_mfma_f32_16x16x32_bf16 v[24:27], v[168:171], v[152:155], v[24:27]
    v_mfma_f32_16x16x32_bf16 v[0:3], v[168:171], v[148:151], v[0:3]
    v_mfma_f32_16x16x32_bf16 v[4:7], v[172:175], v[148:151], v[4:7]
    v_mfma_f32_16x16x32_bf16 v[8:11], v[176:179], v[148:151], v[8:11]
    v_mfma_f32_16x16x32_bf16 v[12:15], v[180:183], v[148:151], v[12:15]
    v_mfma_f32_16x16x32_bf16 v[16:19], v[148:151], v[184:187], v[16:19]
    v_mfma_f32_16x16x32_bf16 v[20:23], v[148:151], v[188:191], v[20:23]
    v_cvt_pk_bf16_f32 v104, v96, v97
    v_cvt_pk_bf16_f32 v105, v98, v99
    v_cvt_pk_bf16_f32 v106, v100, v101
    v_cvt_pk_bf16_f32 v107, v102, v103
    ds_write_b64 v215, v[104:105] offset:2048
    ds_write_b64 v215, v[106:107] offset:2560
    ds_write_b32 v223, v224 offset:4
    v_cvt_pk_bf16_f32 v120, v80, v81
    v_cvt_pk_bf16_f32 v121, v82, v83
    v_cvt_pk_bf16_f32 v122, v84, v85
    v_cvt_pk_bf16_f32 v123, v86, v87
    v_cvt_pk_bf16_f32 v148, v88, v89
    v_cvt_pk_bf16_f32 v149, v90, v91
    v_cvt_pk_bf16_f32 v158, v92, v93
    v_cvt_pk_bf16_f32 v159, v94, v95
    v_cvt_pk_bf16_f32 v136, v72, v73
    v_cvt_pk_bf16_f32 v137, v74, v75
    v_cvt_pk_bf16_f32 v138, v76, v77
    v_cvt_pk_bf16_f32 v139, v78, v79
    v_cvt_pk_bf16_f32 v116, v56, v57
    v_cvt_pk_bf16_f32 v117, v58, v59
    v_cvt_pk_bf16_f32 v118, v60, v61
    v_cvt_pk_bf16_f32 v119, v62, v63
    v_mfma_f32_16x16x32_bf16 v[188:191], v[120:123], v[136:139], v[232:235]
    s_nop 0
    v_mfma_f32_16x16x32_bf16 v[184:187], v[116:119], v[136:139], v[228:231]
    v_cvt_pk_bf16_f32 v132, v48, v49
    v_cvt_pk_bf16_f32 v133, v50, v51
    v_cvt_pk_bf16_f32 v134, v52, v53
    v_cvt_pk_bf16_f32 v135, v54, v55
    v_cvt_pk_bf16_f32 v112, v32, v33
    v_cvt_pk_bf16_f32 v113, v34, v35
    v_cvt_pk_bf16_f32 v114, v36, v37
    v_cvt_pk_bf16_f32 v115, v38, v39
    v_mfma_f32_16x16x32_bf16 v[180:183], v[116:119], v[132:135], v[232:235]
    s_nop 0
    v_mfma_f32_16x16x32_bf16 v[176:179], v[112:115], v[132:135], v[228:231]
    v_cvt_pk_bf16_f32 v128, v24, v25
    v_cvt_pk_bf16_f32 v129, v26, v27
    v_cvt_pk_bf16_f32 v130, v28, v29
    v_cvt_pk_bf16_f32 v131, v30, v31
    v_cvt_pk_bf16_f32 v108, v8, v9
    v_cvt_pk_bf16_f32 v109, v10, v11
    v_cvt_pk_bf16_f32 v110, v12, v13
    v_cvt_pk_bf16_f32 v111, v14, v15
    v_mfma_f32_16x16x32_bf16 v[172:175], v[112:115], v[128:131], v[232:235]
    s_nop 0
    v_mfma_f32_16x16x32_bf16 v[168:171], v[108:111], v[128:131], v[228:231]
    v_cvt_pk_bf16_f32 v124, v0, v1
    v_cvt_pk_bf16_f32 v125, v2, v3
    v_cvt_pk_bf16_f32 v126, v4, v5
    v_cvt_pk_bf16_f32 v127, v6, v7
    s_nop 1
    v_mfma_f32_16x16x32_bf16 v[164:167], v[108:111], v[124:127], v[232:235]
    v_cvt_pk_bf16_f32 v146, v64, v65
    v_cvt_pk_bf16_f32 v147, v66, v67
    v_cvt_pk_bf16_f32 v156, v68, v69
    v_cvt_pk_bf16_f32 v157, v70, v71
    v_cvt_pk_bf16_f32 v144, v40, v41
    v_cvt_pk_bf16_f32 v145, v42, v43
    v_cvt_pk_bf16_f32 v154, v44, v45
    v_cvt_pk_bf16_f32 v155, v46, v47
    v_cvt_pk_bf16_f32 v142, v16, v17
    v_cvt_pk_bf16_f32 v143, v18, v19
    v_cvt_pk_bf16_f32 v152, v20, v21
    v_cvt_pk_bf16_f32 v153, v22, v23
    s_mov_b32 s41, 0x3e3504f3
    s_mov_b32 s42, 0x3fb8aa3b
    s_mov_b32 s43, 0xffff0000
    v_max_f32 v12, v184, v185
    v_max_f32 v13, v186, v187
    v_max_f32 v14, v188, v189
    v_max_f32 v15, v190, v191
    v_max_f32 v8, v176, v177
    v_max_f32 v9, v178, v179
    v_max_f32 v10, v180, v181
    v_max_f32 v11, v182, v183
    v_max_f32 v4, v168, v169
    v_max_f32 v5, v170, v171
    v_max_f32 v6, v172, v173
    v_max_f32 v7, v174, v175
    v_cvt_pk_bf16_f32 v22, v12, v13
    v_cvt_pk_bf16_f32 v23, v14, v15
    v_cvt_pk_bf16_f32 v20, v8, v9
    v_cvt_pk_bf16_f32 v21, v10, v11
    v_cvt_pk_bf16_f32 v18, v4, v5
    v_cvt_pk_bf16_f32 v19, v6, v7
    v_lshlrev_b32 v12, 16, v22
    v_and_b32 v13, s43, v22
    v_lshlrev_b32 v14, 16, v23
    v_and_b32 v15, s43, v23
    v_lshlrev_b32 v8, 16, v20
    v_and_b32 v9, s43, v20
    v_lshlrev_b32 v10, 16, v21
    v_and_b32 v11, s43, v21
    v_lshlrev_b32 v4, 16, v18
    v_and_b32 v5, s43, v18
    v_lshlrev_b32 v6, 16, v19
    v_and_b32 v7, s43, v19
    v_pk_mul_f32 v[12:13], v[12:13], s[40:41] op_sel:[0,1] op_sel_hi:[1,1]
    v_pk_mul_f32 v[14:15], v[14:15], s[40:41] op_sel:[0,1] op_sel_hi:[1,1]
    v_pk_mul_f32 v[8:9], v[8:9], s[40:41] op_sel:[0,1] op_sel_hi:[1,1]
    v_pk_mul_f32 v[10:11], v[10:11], s[40:41] op_sel:[0,1] op_sel_hi:[1,1]
    v_pk_mul_f32 v[4:5], v[4:5], s[40:41] op_sel:[0,1] op_sel_hi:[1,1]
    v_pk_mul_f32 v[6:7], v[6:7], s[40:41] op_sel:[0,1] op_sel_hi:[1,1]
    v_cvt_pk_bf16_f32 v22, v12, v13
    v_cvt_pk_bf16_f32 v23, v14, v15
    v_cvt_pk_bf16_f32 v20, v8, v9
    v_cvt_pk_bf16_f32 v21, v10, v11
    v_cvt_pk_bf16_f32 v18, v4, v5
    v_cvt_pk_bf16_f32 v19, v6, v7
    v_lshlrev_b32 v12, 16, v22
    v_and_b32 v13, s43, v22
    v_lshlrev_b32 v14, 16, v23
    v_and_b32 v15, s43, v23
    v_lshlrev_b32 v8, 16, v20
    v_and_b32 v9, s43, v20
    v_lshlrev_b32 v10, 16, v21
    v_and_b32 v11, s43, v21
    v_lshlrev_b32 v4, 16, v18
    v_and_b32 v5, s43, v18
    v_lshlrev_b32 v6, 16, v19
    v_and_b32 v7, s43, v19
L_ex_42:
    ds_read_b32 v216, v223 offset:0
    s_waitcnt lgkmcnt(0)
    v_readfirstlane_b32 s44, v216
    s_nop 0
    s_cmp_eq_u32 s44, 0
    s_cbranch_scc1 L_ex_42
    ds_read_b128 v[104:107], v214
    ds_read_b64 v[140:141], v215 offset:1024
    ds_read_b64 v[150:151], v215 offset:1536
L_attn:
    s_waitcnt lgkmcnt(0)
    v_mfma_f32_16x16x32_bf16 v[160:163], v[104:107], v[124:127], v[236:239]
    s_nop 7
    v_max_f32 v0, v160, v161
    v_max_f32 v1, v162, v163
    v_max_f32 v2, v164, v165
    v_max_f32 v3, v166, v167
    v_cvt_pk_bf16_f32 v16, v0, v1
    v_cvt_pk_bf16_f32 v17, v2, v3
    v_lshlrev_b32 v0, 16, v16
    v_and_b32 v1, s43, v16
    v_lshlrev_b32 v2, 16, v17
    v_and_b32 v3, s43, v17
    v_pk_mul_f32 v[0:1], v[0:1], s[40:41] op_sel:[0,1] op_sel_hi:[1,1]
    v_pk_mul_f32 v[2:3], v[2:3], s[40:41] op_sel:[0,1] op_sel_hi:[1,1]
    v_cvt_pk_bf16_f32 v16, v0, v1
    v_cvt_pk_bf16_f32 v17, v2, v3
    v_lshlrev_b32 v0, 16, v16
    v_and_b32 v1, s43, v16
    v_lshlrev_b32 v2, 16, v17
    v_and_b32 v3, s43, v17
    v_max_f32 v35, v12, v13
    v_max_f32 v34, v8, v9
    v_max_f32 v33, v4, v5
    v_max_f32 v32, v0, v1
    v_max3_f32 v35, v35, v14, v15
    v_max3_f32 v34, v34, v10, v11
    v_max3_f32 v33, v33, v6, v7
    v_max3_f32 v32, v32, v2, v3
    s_nop 1
    v_permlane32_swap_b32 v32, v33
    v_permlane32_swap_b32 v34, v35
    v_max_f32 v32, v32, v33
    v_max_f32 v34, v34, v35
    s_nop 1
    v_permlane16_swap_b32 v32, v34
    v_max_f32 v32, v32, v34
    v_mul_f32 v32, s42, v32
    v_mov_b32 v34, v32
    s_nop 1
    v_permlane16_swap_b32 v32, v34
    v_mov_b32 v33, v32
    v_mov_b32 v35, v34
    s_nop 0
    v_permlane32_swap_b32 v32, v33
    v_permlane32_swap_b32 v34, v35
    v_pk_fma_f32 v[12:13], v[12:13], s[42:43], v[34:35] op_sel:[0,0,1] op_sel_hi:[1,0,1] neg_lo:[0,0,1] neg_hi:[0,0,1]
    v_pk_fma_f32 v[14:15], v[14:15], s[42:43], v[34:35] op_sel:[0,0,1] op_sel_hi:[1,0,1] neg_lo:[0,0,1] neg_hi:[0,0,1]
    v_pk_fma_f32 v[8:9], v[8:9], s[42:43], v[34:35] op_sel:[0,0,0] op_sel_hi:[1,0,0] neg_lo:[0,0,1] neg_hi:[0,0,1]
    v_pk_fma_f32 v[10:11], v[10:11], s[42:43], v[34:35] op_sel:[0,0,0] op_sel_hi:[1,0,0] neg_lo:[0,0,1] neg_hi:[0,0,1]
    v_pk_fma_f32 v[4:5], v[4:5], s[42:43], v[32:33] op_sel:[0,0,1] op_sel_hi:[1,0,1] neg_lo:[0,0,1] neg_hi:[0,0,1]
    v_pk_fma_f32 v[6:7], v[6:7], s[42:43], v[32:33] op_sel:[0,0,1] op_sel_hi:[1,0,1] neg_lo:[0,0,1] neg_hi:[0,0,1]
    v_pk_fma_f32 v[0:1], v[0:1], s[42:43], v[32:33] op_sel:[0,0,0] op_sel_hi:[1,0,0] neg_lo:[0,0,1] neg_hi:[0,0,1]
    v_pk_fma_f32 v[2:3], v[2:3], s[42:43], v[32:33] op_sel:[0,0,0] op_sel_hi:[1,0,0] neg_lo:[0,0,1] neg_hi:[0,0,1]
    v_exp_f32 v12, v12
    v_exp_f32 v13, v13
    v_exp_f32 v14, v14
    v_exp_f32 v15, v15
    v_exp_f32 v8, v8
    v_exp_f32 v9, v9
    v_exp_f32 v10, v10
    v_exp_f32 v11, v11
    v_exp_f32 v4, v4
    v_exp_f32 v5, v5
    v_exp_f32 v6, v6
    v_exp_f32 v7, v7
    v_exp_f32 v0, v0
    v_exp_f32 v1, v1
    v_exp_f32 v2, v2
    v_exp_f32 v3, v3
    v_pk_add_f32 v[22:23], v[12:13], v[14:15]
    v_pk_add_f32 v[20:21], v[8:9], v[10:11]
    v_pk_add_f32 v[18:19], v[4:5], v[6:7]
    v_pk_add_f32 v[16:17], v[0:1], v[2:3]
    v_add_f32 v43, v22, v23
    v_add_f32 v42, v20, v21
    v_add_f32 v41, v18, v19
    v_add_f32 v40, v16, v17
    s_nop 1
    v_permlane32_swap_b32 v40, v41
    v_permlane32_swap_b32 v42, v43
    v_add_f32 v40, v40, v41
    v_add_f32 v42, v42, v43
    s_nop 1
    v_permlane16_swap_b32 v40, v42
    v_add_f32 v40, v40, v42
    v_rcp_f32 v40, v40
    s_nop 0
    v_mov_b32 v42, v40
    s_nop 1
    v_permlane16_swap_b32 v40, v42
    v_mov_b32 v41, v40
    v_mov_b32 v43, v42
    s_nop 0
    v_permlane32_swap_b32 v40, v41
    v_permlane32_swap_b32 v42, v43
    v_pk_mul_f32 v[12:13], v[12:13], v[42:43] op_sel:[0,1] op_sel_hi:[1,1]
    v_pk_mul_f32 v[14:15], v[14:15], v[42:43] op_sel:[0,1] op_sel_hi:[1,1]
    v_pk_mul_f32 v[8:9], v[8:9], v[42:43] op_sel:[0,0] op_sel_hi:[1,0]
    v_pk_mul_f32 v[10:11], v[10:11], v[42:43] op_sel:[0,0] op_sel_hi:[1,0]
    v_pk_mul_f32 v[4:5], v[4:5], v[40:41] op_sel:[0,1] op_sel_hi:[1,1]
    v_pk_mul_f32 v[6:7], v[6:7], v[40:41] op_sel:[0,1] op_sel_hi:[1,1]
    v_pk_mul_f32 v[0:1], v[0:1], v[40:41] op_sel:[0,0] op_sel_hi:[1,0]
    v_pk_mul_f32 v[2:3], v[2:3], v[40:41] op_sel:[0,0] op_sel_hi:[1,0]
    v_cvt_pk_bf16_f32 v22, v12, v13
    v_cvt_pk_bf16_f32 v23, v14, v15
    v_cvt_pk_bf16_f32 v20, v8, v9
    v_cvt_pk_bf16_f32 v21, v10, v11
    v_cvt_pk_bf16_f32 v18, v4, v5
    v_cvt_pk_bf16_f32 v19, v6, v7
    v_cvt_pk_bf16_f32 v16, v0, v1
    v_cvt_pk_bf16_f32 v17, v2, v3
    v_perm_b32 v60, v22, v22, v212
    v_perm_b32 v61, v22, v22, v213
    v_perm_b32 v62, v23, v23, v212
    v_perm_b32 v63, v23, v23, v213
    v_perm_b32 v56, v20, v20, v212
    v_perm_b32 v57, v20, v20, v213
    v_perm_b32 v58, v21, v21, v212
    v_perm_b32 v59, v21, v21, v213
    v_perm_b32 v52, v18, v18, v212
    v_perm_b32 v53, v18, v18, v213
    v_perm_b32 v54, v19, v19, v212
    v_perm_b32 v55, v19, v19, v213
    v_perm_b32 v48, v16, v16, v212
    v_perm_b32 v49, v16, v16, v213
    v_perm_b32 v50, v17, v17, v212
    v_perm_b32 v51, v17, v17, v213
    v_mfma_f32_16x16x32_bf16 v[88:91], v[146:149], v[60:63], 0
    v_mfma_f32_16x16x32_bf16 v[92:95], v[156:159], v[60:63], 0
    v_mfma_f32_16x16x32_bf16 v[80:83], v[144:147], v[56:59], 0
    v_mfma_f32_16x16x32_bf16 v[84:87], v[154:157], v[56:59], 0
    v_mfma_f32_16x16x32_bf16 v[72:75], v[142:145], v[52:55], 0
    v_mfma_f32_16x16x32_bf16 v[76:79], v[152:155], v[52:55], 0
    v_mfma_f32_16x16x32_bf16 v[64:67], v[140:143], v[48:51], 0
    v_mfma_f32_16x16x32_bf16 v[68:71], v[150:153], v[48:51], 0
    s_lshl_b32 s41, s6, 3
    s_lshr_b32 s42, s3, 1
    s_lshl_b32 s43, s42, 2
    s_add_u32 s41, s41, s43
    s_lshl_b32 s41, s41, 5
    s_lshl_b32 s43, s7, 1
    s_and_b32 s44, s3, 1
    s_add_u32 s43, s43, s44
    s_add_u32 s41, s41, s43
    s_lshl_b32 s41, s41, 10
    s_add_u32 s41, s41, 98304
    v_cvt_pk_bf16_f32 v12, v88, v89
    v_cvt_pk_bf16_f32 v13, v90, v91
    v_cvt_pk_bf16_f32 v14, v92, v93
    v_cvt_pk_bf16_f32 v15, v94, v95
    buffer_store_dwordx4 v[12:15], v211, s[36:39], s41 offen sc1
    s_sub_u32 s41, s41, 32768
    v_cvt_pk_bf16_f32 v8, v80, v81
    v_cvt_pk_bf16_f32 v9, v82, v83
    v_cvt_pk_bf16_f32 v10, v84, v85
    v_cvt_pk_bf16_f32 v11, v86, v87
    buffer_store_dwordx4 v[8:11], v211, s[36:39], s41 offen sc1
    s_sub_u32 s41, s41, 32768
    v_cvt_pk_bf16_f32 v4, v72, v73
    v_cvt_pk_bf16_f32 v5, v74, v75
    v_cvt_pk_bf16_f32 v6, v76, v77
    v_cvt_pk_bf16_f32 v7, v78, v79
    buffer_store_dwordx4 v[4:7], v211, s[36:39], s41 offen sc1
    s_sub_u32 s41, s41, 32768
    v_cvt_pk_bf16_f32 v0, v64, v65
    v_cvt_pk_bf16_f32 v1, v66, v67
    v_cvt_pk_bf16_f32 v2, v68, v69
    v_cvt_pk_bf16_f32 v3, v70, v71
    buffer_store_dwordx4 v[0:3], v211, s[36:39], s41 offen sc1
    s_lshl_b32 s41, s6, 4
    s_add_u32 s41, s41, s7
    s_lshl_b32 s41, s41, 7
    s_lshl_b32 s43, s3, 2
    s_add_u32 s41, s41, s43
    s_add_u32 s41, s41, 8388608
    v_mov_b32 v216, 0
    v_lshrrev_b32 v218, 2, v210
    v_lshlrev_b32 v218, 7, v218
    v_and_b32 v221, 3, v210
    v_lshl_add_u32 v218, v221, 2, v218
    s_lshl_b32 s44, s8, 11
    s_add_u32 s44, s44, 8388608
    s_mov_b32 s47, 1048576
    s_lshl_b32 s45, s8, 3
    s_lshl_b32 s46, s3, 1
    s_add_u32 s45, s45, s46
    s_lshl_b32 s45, s45, 15
    s_add_u32 s45, s45, 0
    v_add_u32 v219, 0x8000, v211
    s_lshl_b32 s46, s10, 10
    s_cmp_lg_u32 s3, 0
    s_cbranch_scc1 L_nep
    buffer_load_dword v220, v218, s[36:39], s44 offen sc1
    s_waitcnt vmcnt(1)
    s_mov_b64 exec, 1
    buffer_store_dword v224, v216, s[36:39], s41 offen sc1
    s_mov_b64 exec, -1
    s_branch L_nef
L_nep:
    s_waitcnt vmcnt(0)
    s_mov_b64 exec, 1
    buffer_store_dword v224, v216, s[36:39], s41 offen sc1
    s_mov_b64 exec, -1
L_nef:
    v_mov_b32 v0, 0
    v_mov_b32 v1, 0
    v_mov_b32 v2, 0
    v_mov_b32 v3, 0
    v_mov_b32 v4, 0
    v_mov_b32 v5, 0
    v_mov_b32 v6, 0
    v_mov_b32 v7, 0
    v_mov_b32 v8, 0
    v_mov_b32 v9, 0
    v_mov_b32 v10, 0
    v_mov_b32 v11, 0
    v_mov_b32 v12, 0
    v_mov_b32 v13, 0
    v_mov_b32 v14, 0
    v_mov_b32 v15, 0
    v_mov_b32 v16, 0
    v_mov_b32 v17, 0
    v_mov_b32 v18, 0
    v_mov_b32 v19, 0
    v_mov_b32 v20, 0
    v_mov_b32 v21, 0
    v_mov_b32 v22, 0
    v_mov_b32 v23, 0
    v_mov_b32 v24, 0
    v_mov_b32 v25, 0
    v_mov_b32 v26, 0
    v_mov_b32 v27, 0
    v_mov_b32 v28, 0
    v_mov_b32 v29, 0
    v_mov_b32 v30, 0
    v_mov_b32 v31, 0
    s_cmp_lg_u32 s3, 0
    s_cbranch_scc1 L_ow_43
    s_waitcnt vmcnt(1)
    s_branch L_oc_45
L_op_44:
    buffer_load_dword v220, v218, s[36:39], s44 offen sc1
    s_sub_u32 s47, s47, 1
    s_waitcnt vmcnt(0)
L_oc_45:
    v_cmp_ne_u32 vcc, 1, v220
    s_nop 0
    s_cmp_eq_u32 vcc_lo, 0
    s_cbranch_scc1 L_os_46
    s_cmp_gt_i32 s47, 0
    s_cbranch_scc1 L_op_44
L_os_46:
    ds_add_u32 v225, v224 offset:0
    s_branch L_og_47
L_ow_43:
    v_mov_b32 v226, 162816
L_lw_48:
    ds_read_b32 v227, v226
    s_waitcnt lgkmcnt(0)
    v_readfirstlane_b32 s40, v227
    s_nop 0
    s_cmp_ge_u32 s40, 64
    s_cbranch_scc0 L_lw_48
L_og_47:
    s_add_u32 s48, s45, s46
    s_add_u32 s46, s46, 4096
    s_and_b32 s46, s46, 16383
    buffer_load_dwordx4 v[96:99], v211, s[36:39], s48 offen offset:0 sc1
    buffer_load_dwordx4 v[100:103], v219, s[36:39], s48 offen offset:0 sc1
    buffer_load_dwordx4 v[104:107], v211, s[36:39], s48 offen offset:1024 sc1
    buffer_load_dwordx4 v[108:111], v219, s[36:39], s48 offen offset:1024 sc1
    buffer_load_dwordx4 v[112:115], v211, s[36:39], s48 offen offset:2048 sc1
    buffer_load_dwordx4 v[116:119], v219, s[36:39], s48 offen offset:2048 sc1
    buffer_load_dwordx4 v[120:123], v211, s[36:39], s48 offen offset:3072 sc1
    buffer_load_dwordx4 v[124:127], v219, s[36:39], s48 offen offset:3072 sc1
    s_add_u32 s49, s45, s46
    s_add_u32 s46, s46, 4096
    s_and_b32 s46, s46, 16383
    buffer_load_dwordx4 v[128:131], v211, s[36:39], s49 offen offset:0 sc1
    buffer_load_dwordx4 v[132:135], v219, s[36:39], s49 offen offset:0 sc1
    buffer_load_dwordx4 v[136:139], v211, s[36:39], s49 offen offset:1024 sc1
    buffer_load_dwordx4 v[140:143], v219, s[36:39], s49 offen offset:1024 sc1
    buffer_load_dwordx4 v[144:147], v211, s[36:39], s49 offen offset:2048 sc1
    buffer_load_dwordx4 v[148:151], v219, s[36:39], s49 offen offset:2048 sc1
    buffer_load_dwordx4 v[152:155], v211, s[36:39], s49 offen offset:3072 sc1
    v_mov_b32 v226, 162824
L_lw_49:
    ds_read_b32 v227, v226
    s_waitcnt lgkmcnt(0)
    v_readfirstlane_b32 s40, v227
    s_nop 0
    s_cmp_ge_u32 s40, 256
    s_cbranch_scc0 L_lw_49
    ds_read_b64_tr_b16 v[32:33], v244 offset:0
    ds_read_b64_tr_b16 v[34:35], v244 offset:2048
    ds_read_b64_tr_b16 v[36:37], v245 offset:0
    ds_read_b64_tr_b16 v[38:39], v245 offset:2048
    ds_read_b64_tr_b16 v[40:41], v246 offset:0
    ds_read_b64_tr_b16 v[42:43], v246 offset:2048
    ds_read_b64_tr_b16 v[44:45], v247 offset:0
    ds_read_b64_tr_b16 v[46:47], v247 offset:2048
    ds_read_b64_tr_b16 v[48:49], v244 offset:4096
    ds_read_b64_tr_b16 v[50:51], v244 offset:6144
    ds_read_b64_tr_b16 v[52:53], v245 offset:4096
    ds_read_b64_tr_b16 v[54:55], v245 offset:6144
    ds_read_b64_tr_b16 v[56:57], v246 offset:4096
    ds_read_b64_tr_b16 v[58:59], v246 offset:6144
    ds_read_b64_tr_b16 v[60:61], v247 offset:4096
    ds_read_b64_tr_b16 v[62:63], v247 offset:6144
    s_mov_b32 s50, 3
    s_cmp_lg_u32 s3, 0
    s_cbranch_scc1 L_g2
    buffer_load_dword v220, v218, s[36:39], s44 offen sc1
L_g2:
    s_waitcnt vmcnt(13) lgkmcnt(8)
    v_mfma_f32_16x16x32_bf16 v[0:3], v[32:35], v[96:99], v[0:3]
    ds_read_b64_tr_b16 v[64:65], v244 offset:8192
    buffer_load_dwordx4 v[156:159], v219, s[36:39], s49 offen offset:3072 sc1
    v_mfma_f32_16x16x32_bf16 v[4:7], v[36:39], v[96:99], v[4:7]
    ds_read_b64_tr_b16 v[66:67], v244 offset:10240
    s_add_u32 s48, s45, s46
    v_mfma_f32_16x16x32_bf16 v[8:11], v[40:43], v[96:99], v[8:11]
    ds_read_b64_tr_b16 v[68:69], v245 offset:8192
    s_add_u32 s46, s46, 4096
    v_mfma_f32_16x16x32_bf16 v[12:15], v[44:47], v[96:99], v[12:15]
    ds_read_b64_tr_b16 v[70:71], v245 offset:10240
    s_and_b32 s46, s46, 16383
    v_mfma_f32_16x16x32_bf16 v[28:31], v[44:47], v[100:103], v[28:31]
    ds_read_b64_tr_b16 v[72:73], v246 offset:8192
    v_mfma_f32_16x16x32_bf16 v[24:27], v[40:43], v[100:103], v[24:27]
    ds_read_b64_tr_b16 v[74:75], v246 offset:10240
    buffer_load_dwordx4 v[96:99], v211, s[36:39], s48 offen offset:0 sc1
    v_mfma_f32_16x16x32_bf16 v[20:23], v[36:39], v[100:103], v[20:23]
    ds_read_b64_tr_b16 v[76:77], v247 offset:8192
    v_mfma_f32_16x16x32_bf16 v[16:19], v[32:35], v[100:103], v[16:19]
    ds_read_b64_tr_b16 v[78:79], v247 offset:10240
    s_waitcnt vmcnt(13) lgkmcnt(8)
    v_mfma_f32_16x16x32_bf16 v[0:3], v[48:51], v[104:107], v[0:3]
    ds_read_b64_tr_b16 v[80:81], v244 offset:12288
    buffer_load_dwordx4 v[100:103], v219, s[36:39], s48 offen offset:0 sc1
    v_mfma_f32_16x16x32_bf16 v[4:7], v[52:55], v[104:107], v[4:7]
    ds_read_b64_tr_b16 v[82:83], v244 offset:14336
    v_mfma_f32_16x16x32_bf16 v[8:11], v[56:59], v[104:107], v[8:11]
    ds_read_b64_tr_b16 v[84:85], v245 offset:12288
    v_mfma_f32_16x16x32_bf16 v[12:15], v[60:63], v[104:107], v[12:15]
    ds_read_b64_tr_b16 v[86:87], v245 offset:14336
    v_mfma_f32_16x16x32_bf16 v[28:31], v[60:63], v[108:111], v[28:31]
    ds_read_b64_tr_b16 v[88:89], v246 offset:12288
    v_mfma_f32_16x16x32_bf16 v[24:27], v[56:59], v[108:111], v[24:27]
    ds_read_b64_tr_b16 v[90:91], v246 offset:14336
    buffer_load_dwordx4 v[104:107], v211, s[36:39], s48 offen offset:1024 sc1
    v_mfma_f32_16x16x32_bf16 v[20:23], v[52:55], v[108:111], v[20:23]
    ds_read_b64_tr_b16 v[92:93], v247 offset:12288
    v_mfma_f32_16x16x32_bf16 v[16:19], v[48:51], v[108:111], v[16:19]
    ds_read_b64_tr_b16 v[94:95], v247 offset:14336
    s_waitcnt vmcnt(13) lgkmcnt(8)
    v_mfma_f32_16x16x32_bf16 v[0:3], v[64:67], v[112:115], v[0:3]
    ds_read_b64_tr_b16 v[32:33], v244 offset:16384
    buffer_load_dwordx4 v[108:111], v219, s[36:39], s48 offen offset:1024 sc1
    v_mfma_f32_16x16x32_bf16 v[4:7], v[68:71], v[112:115], v[4:7]
    ds_read_b64_tr_b16 v[34:35], v244 offset:18432
    v_mfma_f32_16x16x32_bf16 v[8:11], v[72:75], v[112:115], v[8:11]
    ds_read_b64_tr_b16 v[36:37], v245 offset:16384
    v_mfma_f32_16x16x32_bf16 v[12:15], v[76:79], v[112:115], v[12:15]
    ds_read_b64_tr_b16 v[38:39], v245 offset:18432
    v_mfma_f32_16x16x32_bf16 v[28:31], v[76:79], v[116:119], v[28:31]
    ds_read_b64_tr_b16 v[40:41], v246 offset:16384
    v_mfma_f32_16x16x32_bf16 v[24:27], v[72:75], v[116:119], v[24:27]
    ds_read_b64_tr_b16 v[42:43], v246 offset:18432
    buffer_load_dwordx4 v[112:115], v211, s[36:39], s48 offen offset:2048 sc1
    v_mfma_f32_16x16x32_bf16 v[20:23], v[68:71], v[116:119], v[20:23]
    ds_read_b64_tr_b16 v[44:45], v247 offset:16384
    v_mfma_f32_16x16x32_bf16 v[16:19], v[64:67], v[116:119], v[16:19]
    ds_read_b64_tr_b16 v[46:47], v247 offset:18432
    s_waitcnt vmcnt(13) lgkmcnt(8)
    v_mfma_f32_16x16x32_bf16 v[0:3], v[80:83], v[120:123], v[0:3]
    ds_read_b64_tr_b16 v[48:49], v244 offset:20480
    buffer_load_dwordx4 v[116:119], v219, s[36:39], s48 offen offset:2048 sc1
    v_mfma_f32_16x16x32_bf16 v[4:7], v[84:87], v[120:123], v[4:7]
    ds_read_b64_tr_b16 v[50:51], v244 offset:22528
    v_mfma_f32_16x16x32_bf16 v[8:11], v[88:91], v[120:123], v[8:11]
    ds_read_b64_tr_b16 v[52:53], v245 offset:20480
    v_mfma_f32_16x16x32_bf16 v[12:15], v[92:95], v[120:123], v[12:15]
    ds_read_b64_tr_b16 v[54:55], v245 offset:22528
    v_mfma_f32_16x16x32_bf16 v[28:31], v[92:95], v[124:127], v[28:31]
    ds_read_b64_tr_b16 v[56:57], v246 offset:20480
    v_mfma_f32_16x16x32_bf16 v[24:27], v[88:91], v[124:127], v[24:27]
    ds_read_b64_tr_b16 v[58:59], v246 offset:22528
    buffer_load_dwordx4 v[120:123], v211, s[36:39], s48 offen offset:3072 sc1
    v_mfma_f32_16x16x32_bf16 v[20:23], v[84:87], v[124:127], v[20:23]
    ds_read_b64_tr_b16 v[60:61], v247 offset:20480
    v_mfma_f32_16x16x32_bf16 v[16:19], v[80:83], v[124:127], v[16:19]
    ds_read_b64_tr_b16 v[62:63], v247 offset:22528
    s_waitcnt vmcnt(13) lgkmcnt(8)
    v_mfma_f32_16x16x32_bf16 v[0:3], v[32:35], v[128:131], v[0:3]
    ds_read_b64_tr_b16 v[64:65], v244 offset:24576
    buffer_load_dwordx4 v[124:127], v219, s[36:39], s48 offen offset:3072 sc1
    v_mfma_f32_16x16x32_bf16 v[4:7], v[36:39], v[128:131], v[4:7]
    ds_read_b64_tr_b16 v[66:67], v244 offset:26624
    s_add_u32 s49, s45, s46
    v_mfma_f32_16x16x32_bf16 v[8:11], v[40:43], v[128:131], v[8:11]
    ds_read_b64_tr_b16 v[68:69], v245 offset:24576
    s_add_u32 s46, s46, 4096
    v_mfma_f32_16x16x32_bf16 v[12:15], v[44:47], v[128:131], v[12:15]
    ds_read_b64_tr_b16 v[70:71], v245 offset:26624
    s_and_b32 s46, s46, 16383
    v_mfma_f32_16x16x32_bf16 v[28:31], v[44:47], v[132:135], v[28:31]
    ds_read_b64_tr_b16 v[72:73], v246 offset:24576
    v_mfma_f32_16x16x32_bf16 v[24:27], v[40:43], v[132:135], v[24:27]
    ds_read_b64_tr_b16 v[74:75], v246 offset:26624
    buffer_load_dwordx4 v[128:131], v211, s[36:39], s49 offen offset:0 sc1
    v_mfma_f32_16x16x32_bf16 v[20:23], v[36:39], v[132:135], v[20:23]
    ds_read_b64_tr_b16 v[76:77], v247 offset:24576
    v_mfma_f32_16x16x32_bf16 v[16:19], v[32:35], v[132:135], v[16:19]
    ds_read_b64_tr_b16 v[78:79], v247 offset:26624
    s_waitcnt vmcnt(13) lgkmcnt(8)
    v_mfma_f32_16x16x32_bf16 v[0:3], v[48:51], v[136:139], v[0:3]
    ds_read_b64_tr_b16 v[80:81], v244 offset:28672
    buffer_load_dwordx4 v[132:135], v219, s[36:39], s49 offen offset:0 sc1
    v_mfma_f32_16x16x32_bf16 v[4:7], v[52:55], v[136:139], v[4:7]
    ds_read_b64_tr_b16 v[82:83], v244 offset:30720
    v_mfma_f32_16x16x32_bf16 v[8:11], v[56:59], v[136:139], v[8:11]
    ds_read_b64_tr_b16 v[84:85], v245 offset:28672
    v_mfma_f32_16x16x32_bf16 v[12:15], v[60:63], v[136:139], v[12:15]
    ds_read_b64_tr_b16 v[86:87], v245 offset:30720
    v_mfma_f32_16x16x32_bf16 v[28:31], v[60:63], v[140:143], v[28:31]
    ds_read_b64_tr_b16 v[88:89], v246 offset:28672
    v_mfma_f32_16x16x32_bf16 v[24:27], v[56:59], v[140:143], v[24:27]
    ds_read_b64_tr_b16 v[90:91], v246 offset:30720
    buffer_load_dwordx4 v[136:139], v211, s[36:39], s49 offen offset:1024 sc1
    v_mfma_f32_16x16x32_bf16 v[20:23], v[52:55], v[140:143], v[20:23]
    ds_read_b64_tr_b16 v[92:93], v247 offset:28672
    v_mfma_f32_16x16x32_bf16 v[16:19], v[48:51], v[140:143], v[16:19]
    ds_read_b64_tr_b16 v[94:95], v247 offset:30720
    s_waitcnt vmcnt(13) lgkmcnt(8)
    v_mfma_f32_16x16x32_bf16 v[0:3], v[64:67], v[144:147], v[0:3]
    ds_read_b64_tr_b16 v[32:33], v244 offset:32768
    buffer_load_dwordx4 v[140:143], v219, s[36:39], s49 offen offset:1024 sc1
    v_mfma_f32_16x16x32_bf16 v[4:7], v[68:71], v[144:147], v[4:7]
    ds_read_b64_tr_b16 v[34:35], v244 offset:34816
    v_mfma_f32_16x16x32_bf16 v[8:11], v[72:75], v[144:147], v[8:11]
    ds_read_b64_tr_b16 v[36:37], v245 offset:32768
    v_mfma_f32_16x16x32_bf16 v[12:15], v[76:79], v[144:147], v[12:15]
    ds_read_b64_tr_b16 v[38:39], v245 offset:34816
    v_mfma_f32_16x16x32_bf16 v[28:31], v[76:79], v[148:151], v[28:31]
    ds_read_b64_tr_b16 v[40:41], v246 offset:32768
    v_mfma_f32_16x16x32_bf16 v[24:27], v[72:75], v[148:151], v[24:27]
    ds_read_b64_tr_b16 v[42:43], v246 offset:34816
    buffer_load_dwordx4 v[144:147], v211, s[36:39], s49 offen offset:2048 sc1
    v_mfma_f32_16x16x32_bf16 v[20:23], v[68:71], v[148:151], v[20:23]
    ds_read_b64_tr_b16 v[44:45], v247 offset:32768
    v_mfma_f32_16x16x32_bf16 v[16:19], v[64:67], v[148:151], v[16:19]
    ds_read_b64_tr_b16 v[46:47], v247 offset:34816
    s_waitcnt vmcnt(13) lgkmcnt(8)
    v_mfma_f32_16x16x32_bf16 v[0:3], v[80:83], v[152:155], v[0:3]
    ds_read_b64_tr_b16 v[48:49], v244 offset:36864
    buffer_load_dwordx4 v[148:151], v219, s[36:39], s49 offen offset:2048 sc1
    v_mfma_f32_16x16x32_bf16 v[4:7], v[84:87], v[152:155], v[4:7]
    ds_read_b64_tr_b16 v[50:51], v244 offset:38912
    v_mfma_f32_16x16x32_bf16 v[8:11], v[88:91], v[152:155], v[8:11]
    ds_read_b64_tr_b16 v[52:53], v245 offset:36864
    v_mfma_f32_16x16x32_bf16 v[12:15], v[92:95], v[152:155], v[12:15]
    ds_read_b64_tr_b16 v[54:55], v245 offset:38912
    v_mfma_f32_16x16x32_bf16 v[28:31], v[92:95], v[156:159], v[28:31]
    ds_read_b64_tr_b16 v[56:57], v246 offset:36864
    v_mfma_f32_16x16x32_bf16 v[24:27], v[88:91], v[156:159], v[24:27]
    ds_read_b64_tr_b16 v[58:59], v246 offset:38912
    buffer_load_dwordx4 v[152:155], v211, s[36:39], s49 offen offset:3072 sc1
    v_mfma_f32_16x16x32_bf16 v[20:23], v[84:87], v[156:159], v[20:23]
    ds_read_b64_tr_b16 v[60:61], v247 offset:36864
    v_mfma_f32_16x16x32_bf16 v[16:19], v[80:83], v[156:159], v[16:19]
    ds_read_b64_tr_b16 v[62:63], v247 offset:38912
    v_add_u32 v244, 0x8000, v244
    v_add_u32 v245, 0x8000, v245
    v_add_u32 v246, 0x8000, v246
    v_add_u32 v247, 0x8000, v247
    s_cmp_lg_u32 s50, 3
    s_cbranch_scc1 L_g2n
    s_cmp_lg_u32 s3, 0
    s_cbranch_scc1 L_ow_50
    s_branch L_oc_52
L_op_51:
    buffer_load_dword v220, v218, s[36:39], s44 offen sc1
    s_sub_u32 s47, s47, 1
    s_waitcnt vmcnt(0)
L_oc_52:
    v_cmp_ne_u32 vcc, 1, v220
    s_nop 0
    s_cmp_eq_u32 vcc_hi, 0
    s_cbranch_scc1 L_os_53
    s_cmp_gt_i32 s47, 0
    s_cbranch_scc1 L_op_51
L_os_53:
    ds_add_u32 v225, v224 offset:52
    s_branch L_og_54
L_ow_50:
    v_mov_b32 v226, 162868
L_lw_55:
    ds_read_b32 v227, v226
    s_waitcnt lgkmcnt(0)
    v_readfirstlane_b32 s40, v227
    s_nop 0
    s_cmp_ge_u32 s40, 64
    s_cbranch_scc0 L_lw_55
L_og_54:
    s_add_u32 s45, s45, 0x4000
L_g2n:
    s_sub_u32 s50, s50, 1
    s_cmp_lg_u32 s50, 0
    s_cbranch_scc1 L_g2
    ds_add_u32 v225, v224 offset:44
    s_waitcnt vmcnt(13) lgkmcnt(8)
    v_mfma_f32_16x16x32_bf16 v[0:3], v[32:35], v[96:99], v[0:3]
    ds_read_b64_tr_b16 v[64:65], v244 offset:8192
    buffer_load_dwordx4 v[156:159], v219, s[36:39], s49 offen offset:3072 sc1
    v_mfma_f32_16x16x32_bf16 v[4:7], v[36:39], v[96:99], v[4:7]
    ds_read_b64_tr_b16 v[66:67], v244 offset:10240
    v_mfma_f32_16x16x32_bf16 v[8:11], v[40:43], v[96:99], v[8:11]
    ds_read_b64_tr_b16 v[68:69], v245 offset:8192
    v_mfma_f32_16x16x32_bf16 v[12:15], v[44:47], v[96:99], v[12:15]
    ds_read_b64_tr_b16 v[70:71], v245 offset:10240
    v_mfma_f32_16x16x32_bf16 v[28:31], v[44:47], v[100:103], v[28:31]
    ds_read_b64_tr_b16 v[72:73], v246 offset:8192
    v_mfma_f32_16x16x32_bf16 v[24:27], v[40:43], v[100:103], v[24:27]
    ds_read_b64_tr_b16 v[74:75], v246 offset:10240
    v_mfma_f32_16x16x32_bf16 v[20:23], v[36:39], v[100:103], v[20:23]
    ds_read_b64_tr_b16 v[76:77], v247 offset:8192
    v_mfma_f32_16x16x32_bf16 v[16:19], v[32:35], v[100:103], v[16:19]
    ds_read_b64_tr_b16 v[78:79], v247 offset:10240
    s_waitcnt vmcnt(12) lgkmcnt(8)
    v_mfma_f32_16x16x32_bf16 v[0:3], v[48:51], v[104:107], v[0:3]
    ds_read_b64_tr_b16 v[80:81], v244 offset:12288
    v_mfma_f32_16x16x32_bf16 v[4:7], v[52:55], v[104:107], v[4:7]
    ds_read_b64_tr_b16 v[82:83], v244 offset:14336
    v_mfma_f32_16x16x32_bf16 v[8:11], v[56:59], v[104:107], v[8:11]
    ds_read_b64_tr_b16 v[84:85], v245 offset:12288
    v_and_b32 v216, 7, v210
    v_mfma_f32_16x16x32_bf16 v[12:15], v[60:63], v[104:107], v[12:15]
    ds_read_b64_tr_b16 v[86:87], v245 offset:14336
    v_lshlrev_b32 v216, 12, v216
    v_mfma_f32_16x16x32_bf16 v[28:31], v[60:63], v[108:111], v[28:31]
    ds_read_b64_tr_b16 v[88:89], v246 offset:12288
    v_mfma_f32_16x16x32_bf16 v[24:27], v[56:59], v[108:111], v[24:27]
    ds_read_b64_tr_b16 v[90:91], v246 offset:14336
    v_mfma_f32_16x16x32_bf16 v[20:23], v[52:55], v[108:111], v[20:23]
    ds_read_b64_tr_b16 v[92:93], v247 offset:12288
    v_mfma_f32_16x16x32_bf16 v[16:19], v[48:51], v[108:111], v[16:19]
    ds_read_b64_tr_b16 v[94:95], v247 offset:14336
    s_waitcnt vmcnt(10) lgkmcnt(8)
    v_mfma_f32_16x16x32_bf16 v[0:3], v[64:67], v[112:115], v[0:3]
    ds_read_b64_tr_b16 v[32:33], v244 offset:16384
    v_mfma_f32_16x16x32_bf16 v[4:7], v[68:71], v[112:115], v[4:7]
    ds_read_b64_tr_b16 v[34:35], v244 offset:18432
    v_mfma_f32_16x16x32_bf16 v[8:11], v[72:75], v[112:115], v[8:11]
    ds_read_b64_tr_b16 v[36:37], v245 offset:16384
    v_mfma_f32_16x16x32_bf16 v[12:15], v[76:79], v[112:115], v[12:15]
    ds_read_b64_tr_b16 v[38:39], v245 offset:18432
    v_mfma_f32_16x16x32_bf16 v[28:31], v[76:79], v[116:119], v[28:31]
    ds_read_b64_tr_b16 v[40:41], v246 offset:16384
    v_mfma_f32_16x16x32_bf16 v[24:27], v[72:75], v[116:119], v[24:27]
    ds_read_b64_tr_b16 v[42:43], v246 offset:18432
    v_mfma_f32_16x16x32_bf16 v[20:23], v[68:71], v[116:119], v[20:23]
    ds_read_b64_tr_b16 v[44:45], v247 offset:16384
    v_mfma_f32_16x16x32_bf16 v[16:19], v[64:67], v[116:119], v[16:19]
    ds_read_b64_tr_b16 v[46:47], v247 offset:18432
    s_waitcnt vmcnt(8) lgkmcnt(8)
    v_mfma_f32_16x16x32_bf16 v[0:3], v[80:83], v[120:123], v[0:3]
    ds_read_b64_tr_b16 v[48:49], v244 offset:20480
    v_mfma_f32_16x16x32_bf16 v[4:7], v[84:87], v[120:123], v[4:7]
    ds_read_b64_tr_b16 v[50:51], v244 offset:22528
    v_mfma_f32_16x16x32_bf16 v[8:11], v[88:91], v[120:123], v[8:11]
    ds_read_b64_tr_b16 v[52:53], v245 offset:20480
    v_mfma_f32_16x16x32_bf16 v[12:15], v[92:95], v[120:123], v[12:15]
    ds_read_b64_tr_b16 v[54:55], v245 offset:22528
    v_mfma_f32_16x16x32_bf16 v[28:31], v[92:95], v[124:127], v[28:31]
    ds_read_b64_tr_b16 v[56:57], v246 offset:20480
    v_mfma_f32_16x16x32_bf16 v[24:27], v[88:91], v[124:127], v[24:27]
    ds_read_b64_tr_b16 v[58:59], v246 offset:22528
    v_mfma_f32_16x16x32_bf16 v[20:23], v[84:87], v[124:127], v[20:23]
    ds_read_b64_tr_b16 v[60:61], v247 offset:20480
    v_mfma_f32_16x16x32_bf16 v[16:19], v[80:83], v[124:127], v[16:19]
    ds_read_b64_tr_b16 v[62:63], v247 offset:22528
    s_waitcnt vmcnt(6) lgkmcnt(8)
    v_mfma_f32_16x16x32_bf16 v[0:3], v[32:35], v[128:131], v[0:3]
    ds_read_b64_tr_b16 v[64:65], v244 offset:24576
    v_mfma_f32_16x16x32_bf16 v[4:7], v[36:39], v[128:131], v[4:7]
    ds_read_b64_tr_b16 v[66:67], v244 offset:26624
    v_mfma_f32_16x16x32_bf16 v[8:11], v[40:43], v[128:131], v[8:11]
    ds_read_b64_tr_b16 v[68:69], v245 offset:24576
    v_mfma_f32_16x16x32_bf16 v[12:15], v[44:47], v[128:131], v[12:15]
    ds_read_b64_tr_b16 v[70:71], v245 offset:26624
    v_mfma_f32_16x16x32_bf16 v[28:31], v[44:47], v[132:135], v[28:31]
    ds_read_b64_tr_b16 v[72:73], v246 offset:24576
    v_mfma_f32_16x16x32_bf16 v[24:27], v[40:43], v[132:135], v[24:27]
    ds_read_b64_tr_b16 v[74:75], v246 offset:26624
    v_mfma_f32_16x16x32_bf16 v[20:23], v[36:39], v[132:135], v[20:23]
    ds_read_b64_tr_b16 v[76:77], v247 offset:24576
    v_mfma_f32_16x16x32_bf16 v[16:19], v[32:35], v[132:135], v[16:19]
    ds_read_b64_tr_b16 v[78:79], v247 offset:26624
    s_waitcnt vmcnt(4) lgkmcnt(8)
    v_mfma_f32_16x16x32_bf16 v[0:3], v[48:51], v[136:139], v[0:3]
    ds_read_b64_tr_b16 v[80:81], v244 offset:28672
    v_mfma_f32_16x16x32_bf16 v[4:7], v[52:55], v[136:139], v[4:7]
    ds_read_b64_tr_b16 v[82:83], v244 offset:30720
    v_mfma_f32_16x16x32_bf16 v[8:11], v[56:59], v[136:139], v[8:11]
    ds_read_b64_tr_b16 v[84:85], v245 offset:28672
    v_mfma_f32_16x16x32_bf16 v[12:15], v[60:63], v[136:139], v[12:15]
    ds_read_b64_tr_b16 v[86:87], v245 offset:30720
    v_mfma_f32_16x16x32_bf16 v[28:31], v[60:63], v[140:143], v[28:31]
    ds_read_b64_tr_b16 v[88:89], v246 offset:28672
    v_mfma_f32_16x16x32_bf16 v[24:27], v[56:59], v[140:143], v[24:27]
    ds_read_b64_tr_b16 v[90:91], v246 offset:30720
    v_mfma_f32_16x16x32_bf16 v[20:23], v[52:55], v[140:143], v[20:23]
    ds_read_b64_tr_b16 v[92:93], v247 offset:28672
    v_mfma_f32_16x16x32_bf16 v[16:19], v[48:51], v[140:143], v[16:19]
    ds_read_b64_tr_b16 v[94:95], v247 offset:30720
    s_waitcnt vmcnt(2) lgkmcnt(8)
    v_mfma_f32_16x16x32_bf16 v[0:3], v[64:67], v[144:147], v[0:3]
    v_mfma_f32_16x16x32_bf16 v[4:7], v[68:71], v[144:147], v[4:7]
    v_mfma_f32_16x16x32_bf16 v[8:11], v[72:75], v[144:147], v[8:11]
    v_mfma_f32_16x16x32_bf16 v[12:15], v[76:79], v[144:147], v[12:15]
    v_mfma_f32_16x16x32_bf16 v[28:31], v[76:79], v[148:151], v[28:31]
    v_mfma_f32_16x16x32_bf16 v[24:27], v[72:75], v[148:151], v[24:27]
    v_mfma_f32_16x16x32_bf16 v[20:23], v[68:71], v[148:151], v[20:23]
    v_mfma_f32_16x16x32_bf16 v[16:19], v[64:67], v[148:151], v[16:19]
    s_waitcnt vmcnt(0) lgkmcnt(0)
    v_mfma_f32_16x16x32_bf16 v[0:3], v[80:83], v[152:155], v[0:3]
    v_mfma_f32_16x16x32_bf16 v[4:7], v[84:87], v[152:155], v[4:7]
    v_mfma_f32_16x16x32_bf16 v[8:11], v[88:91], v[152:155], v[8:11]
    v_mfma_f32_16x16x32_bf16 v[12:15], v[92:95], v[152:155], v[12:15]
    v_mfma_f32_16x16x32_bf16 v[28:31], v[92:95], v[156:159], v[28:31]
    v_mfma_f32_16x16x32_bf16 v[24:27], v[88:91], v[156:159], v[24:27]
    v_mfma_f32_16x16x32_bf16 v[20:23], v[84:87], v[156:159], v[20:23]
    v_mfma_f32_16x16x32_bf16 v[16:19], v[80:83], v[156:159], v[16:19]
    v_bfe_u32 v217, v210, 4, 1
    v_lshl_add_u32 v216, v217, 5, v216
    v_lshrrev_b32 v217, 5, v210
    v_lshl_add_u32 v216, v217, 4, v216
    v_bfe_u32 v217, v210, 3, 1
    v_lshl_add_u32 v216, v217, 6, v216
    s_lshl_b32 s41, s8, 2
    s_add_u32 s41, s41, s3
    s_lshl_b32 s41, s41, 17
    s_lshl_b32 s42, s11, 7
    s_add_u32 s41, s41, s42
    v_cvt_pk_bf16_f32 v32, v0, v1
    v_cvt_pk_bf16_f32 v33, v2, v3
    v_cvt_pk_bf16_f32 v34, v4, v5
    v_cvt_pk_bf16_f32 v35, v6, v7
    v_cvt_pk_bf16_f32 v36, v8, v9
    v_cvt_pk_bf16_f32 v37, v10, v11
    v_cvt_pk_bf16_f32 v38, v12, v13
    v_cvt_pk_bf16_f32 v39, v14, v15
    v_permlane16_swap_b32 v32, v34
    v_permlane16_swap_b32 v33, v35
    v_permlane16_swap_b32 v36, v38
    v_permlane16_swap_b32 v37, v39
    v_mov_b32 v48, v32
    v_mov_b32 v49, v33
    v_mov_b32 v50, v34
    v_mov_b32 v51, v35
    v_mov_b32_dpp v32, v36 row_ror:8 row_mask:0xf bank_mask:0xc
    v_mov_b32_dpp v33, v37 row_ror:8 row_mask:0xf bank_mask:0xc
    v_mov_b32_dpp v34, v38 row_ror:8 row_mask:0xf bank_mask:0xc
    v_mov_b32_dpp v35, v39 row_ror:8 row_mask:0xf bank_mask:0xc
    v_mov_b32_dpp v36, v48 row_ror:8 row_mask:0xf bank_mask:0x3
    v_mov_b32_dpp v37, v49 row_ror:8 row_mask:0xf bank_mask:0x3
    v_mov_b32_dpp v38, v50 row_ror:8 row_mask:0xf bank_mask:0x3
    v_mov_b32_dpp v39, v51 row_ror:8 row_mask:0xf bank_mask:0x3
    buffer_store_dwordx4 v[32:35], v216, s[32:35], s41 offen sc1 nt
    s_add_u32 s41, s41, 0x8000
    buffer_store_dwordx4 v[36:39], v216, s[32:35], s41 offen sc1 nt
    s_add_u32 s41, s41, 0x8000
    v_cvt_pk_bf16_f32 v40, v16, v17
    v_cvt_pk_bf16_f32 v41, v18, v19
    v_cvt_pk_bf16_f32 v42, v20, v21
    v_cvt_pk_bf16_f32 v43, v22, v23
    v_cvt_pk_bf16_f32 v44, v24, v25
    v_cvt_pk_bf16_f32 v45, v26, v27
    v_cvt_pk_bf16_f32 v46, v28, v29
    v_cvt_pk_bf16_f32 v47, v30, v31
    v_permlane16_swap_b32 v40, v42
    v_permlane16_swap_b32 v41, v43
    v_permlane16_swap_b32 v44, v46
    v_permlane16_swap_b32 v45, v47
    v_mov_b32 v48, v40
    v_mov_b32 v49, v41
    v_mov_b32 v50, v42
    v_mov_b32 v51, v43
    v_mov_b32_dpp v40, v44 row_ror:8 row_mask:0xf bank_mask:0xc
    v_mov_b32_dpp v41, v45 row_ror:8 row_mask:0xf bank_mask:0xc
    v_mov_b32_dpp v42, v46 row_ror:8 row_mask:0xf bank_mask:0xc
    v_mov_b32_dpp v43, v47 row_ror:8 row_mask:0xf bank_mask:0xc
    v_mov_b32_dpp v44, v48 row_ror:8 row_mask:0xf bank_mask:0x3
    v_mov_b32_dpp v45, v49 row_ror:8 row_mask:0xf bank_mask:0x3
    v_mov_b32_dpp v46, v50 row_ror:8 row_mask:0xf bank_mask:0x3
    v_mov_b32_dpp v47, v51 row_ror:8 row_mask:0xf bank_mask:0x3
    buffer_store_dwordx4 v[40:43], v216, s[32:35], s41 offen sc1 nt
    s_add_u32 s41, s41, 0x8000
    buffer_store_dwordx4 v[44:47], v216, s[32:35], s41 offen sc1 nt
    s_add_u32 s41, s41, 0x8000
L_end:
    s_endpgm

.section .rodata,"a"
.p2align 6
.amdhsa_kernel concat_heads__sliding_local_dilated__spectral_fnet__prompt_kernel
  .amdhsa_next_free_vgpr 256
  .amdhsa_next_free_sgpr 102
  .amdhsa_accum_offset 256
  .amdhsa_group_segment_fixed_size 0
  .amdhsa_kernarg_size 88
  .amdhsa_user_sgpr_count 2
  .amdhsa_user_sgpr_kernarg_segment_ptr 1
  .amdhsa_system_sgpr_workgroup_id_x 1
.end_amdhsa_kernel
```
